```python
import torch

def _softmax(x, axis=-1):
    return torch.softmax(x, dim=axis)
def _gelu(x):
    return torch.nn.functional.gelu(x, approximate="tanh")
def _silu(x):
    return torch.nn.functional.silu(x)
def _sigmoid(x):
    return torch.sigmoid(x)
def _layernorm(x, axis=-1, eps=1e-5):
    m = x.mean(dim=axis, keepdim=True)
    v = x.var(dim=axis, keepdim=True, unbiased=False)
    return (x - m) / torch.sqrt(v + eps)
def _scatter_add(tgt, idx, src, axis=0):
    return tgt.clone().index_add_(axis, idx, src)
def _segment_sum(src, seg, n):
    out = torch.zeros((n,) + src.shape[1:], dtype=src.dtype)
    return out.index_add_(0, seg, src)
def _pad(x, pw):
    flat = tuple(v for pair in reversed(pw) for v in pair)
    return torch.nn.functional.pad(x, flat)

kernel_name = 'standalone__batchnorm__sampling'

def setup_inputs():

    _w = (lambda a: (lambda t: t.to(torch.bfloat16) if t.is_floating_point() else t)(torch.as_tensor(a)))
    B, S, C = 1024, 8, 1024
    K = 3
    return {
        "x": _w((lambda *s: torch.randn(*s, dtype=torch.bfloat16) * 0.05)(B, S, C)),
        "w": _w((lambda *s: torch.randn(*s, dtype=torch.bfloat16) * 0.05)(K, C, C) * (1.0 / (K * C) ** 0.5)),
        "mean": _w((lambda *s: torch.randn(*s, dtype=torch.bfloat16) * 0.05)(C) * 0.1),
        "var": _w(torch.abs((lambda *s: torch.randn(*s, dtype=torch.bfloat16) * 0.05)(C)) + 0.5),
        "g": _w((lambda *s: torch.randn(*s, dtype=torch.bfloat16) * 0.05)(C) + 1.0),
        "b": _w((lambda *s: torch.randn(*s, dtype=torch.bfloat16) * 0.05)(C) * 0.1),
    }

def reference(x, w, mean, var, g, b):
    K = 3
    P = K // 2
    S = x.shape[1]
    xp = _pad(x, ((0, 0), (P, P), (0, 0)))
    y = sum(torch.einsum('bsc,cd->bsd', xp[:, k:k + S, :], w[k]) for k in range(K))
    inv_std = 1.0 / torch.sqrt(var + 1e-5)
    y = (y - mean) * (g * inv_std) + b
    return _silu(y)
```

```asm
; @launch grid=(256,1,1) block=(512,1,1) lds=163840
.amdgcn_target "amdgcn-amd-amdhsa--gfx950"
.text
.globl standalone__batchnorm__sampling_kernel
.p2align 8
.type standalone__batchnorm__sampling_kernel,@function
standalone__batchnorm__sampling_kernel:
    s_load_dwordx4 s[20:23], s[0:1], 0
    s_cmp_ge_u32 s2, 256
    s_cbranch_scc1 L_end
    s_getpc_b64 s[30:31]
L_pc:
    v_lshlrev_b32 v4, 5, v0
    v_min_u32 v4, L_end-L_pc, v4
    global_load_dword v127, v4, s[30:31]
    v_readfirstlane_b32 s18, v0
    s_bfe_u32 s16, s2, 0x50001
    s_lshr_b32 s17, s2, 6
    s_and_b32 s3, s2, 1
    s_lshl1_add_u32 s17, s17, s3
    s_lshl_b32 s39, s16, 19
    s_lshl_b32 s17, s17, 8
    s_bfe_u32 s38, s18, 0x20006
    v_and_b32 v0, 63, v0
    s_bitcmp1_b32 s18, 8
    s_cbranch_scc0 L_compute
    v_lshrrev_b32 v8, 4, v0
    v_lshrrev_b32 v1, 3, v0
    v_lshlrev_b32 v1, 14, v1
    v_xor_b32 v3, v0, v8
    v_and_b32 v3, 7, v3
    v_lshl_add_u32 v1, v3, 4, v1
    s_lshl_b32 s46, s38, 12
    s_lshr_b32 s49, s46, 1
    v_add_u32 v1, s49, v1
    v_xor_b32 v2, 64, v1
    v_add_u32 v3, 2*130048, v1
    v_add_u32 v4, 3*130048, v2
    v_add_u32 v2, 130048, v2
    s_and_b32 s36, s38, 1
    s_lshl_b32 s36, s36, 1
    v_lshl_or_b32 v5, v8, 2, s36
    v_and_b32 v6, 15, v0
    v_xor_b32 v5, v5, v6
    v_lshlrev_b32 v5, 4, v5
    v_lshl_add_u32 v5, v8, 11, v5
    s_lshl2_add_u32 s36, s46, s17
    v_add_u32 v5, s36, v5
    v_add_u32 v6, 7168, v5
    s_bitset1_b32 s49, 16
    s_mov_b32 s44, 0
    s_movk_i32 s48, 0x4000
    s_movk_i32 s51, 0x2000
    s_movk_i32 s52, 0x80
    s_mov_b32 s54, 0
    s_mov_b32 s55, 0x200000
    s_lshl_b32 s56, s55, 1
    s_lshr_b32 s57, s55, 5
    s_mov_b32 s47, s49
    s_add_u32 s50, s49, 98304
    s_mov_b32 s7, 0x20000
    s_mov_b32 s11, s7
    s_lshl_b32 s6, s57, 3
    s_add_u32 s10, s55, s56
    s_add_u32 s36, s30, L_go-L_pc
    s_addc_u32 s37, s31, 0
    s_waitcnt lgkmcnt(0)
    s_mov_b64 s[8:9], s[22:23]
L_iw:
    s_add_u32 m0, s47, 8192
    s_add_u32 s58, s47, 24576
    buffer_load_dwordx4 v5, s[8:11], s55 offen lds
    buffer_load_dwordx4 v6, s[8:11], s55 offen offset:1024 lds
    s_addk_i32 m0, 8192
    s_add_u32 s55, s55, s57
    buffer_load_dwordx4 v5, s[8:11], s56 offen lds
    buffer_load_dwordx4 v6, s[8:11], s56 offen offset:1024 lds
    s_mov_b32 m0, s47
    s_add_u32 s56, s56, s57
    buffer_load_dwordx4 v5, s[8:11], s54 offen lds
    buffer_load_dwordx4 v6, s[8:11], s54 offen offset:1024 lds
    s_add_u32 s54, s54, s57
    s_cmp_eq_u32 s58, s50
    s_cselect_b32 s47, s49, s58
    s_setpc_b64 s[36:37]
L_ix:
    s_mov_b32 m0, s46
    s_xor_b32 s46, s46, s48
    buffer_load_dwordx4 v1, s[4:7], s44 offen lds
    buffer_load_dwordx4 v2, s[4:7], s44 offen offset:1024 lds
    buffer_load_dwordx4 v3, s[4:7], s44 offen offset:2048 lds
    buffer_load_dwordx4 v4, s[4:7], s44 offen offset:3072 lds
    s_xor_b32 s48, s48, 0x8000
    s_add_u32 s44, s44, s51
    s_sub_u32 s51, s52, s51
    s_setpc_b64 s[36:37]
L_go:
    s_add_u32 s4, s20, s39
    s_addc_u32 s5, s21, 0
    s_call_b64 s[36:37], L_ix
    s_call_b64 s[36:37], L_ix
    s_waitcnt vmcnt(4)
    s_barrier
    s_call_b64 s[36:37], L_iw
    s_waitcnt vmcnt(6)
    s_barrier
    s_call_b64 s[36:37], L_iw
    s_call_b64 s[36:37], L_ix
    s_call_b64 s[36:37], L_ix
    s_waitcnt vmcnt(14)
    s_barrier
    s_call_b64 s[36:37], L_iw
    s_call_b64 s[36:37], L_iw
    s_call_b64 s[36:37], L_ix
    s_waitcnt vmcnt(16)
    s_barrier
    s_call_b64 s[36:37], L_ix
    s_call_b64 s[36:37], L_iw
    s_load_dwordx8 s[24:31], s[0:1], 16
    s_load_dwordx2 s[34:35], s[0:1], 64
    v_lshl_add_u32 v12, v0, 2, s17
    s_waitcnt lgkmcnt(0)
    global_load_dword v16, v12, s[24:25]
    global_load_dword v17, v12, s[26:27]
    global_load_dword v18, v12, s[28:29]
    global_load_dword v19, v12, s[30:31]
    s_mov_b32 s53, 0
L_ld3:
    s_waitcnt vmcnt(16)
    s_barrier
    s_call_b64 s[36:37], L_ix
    s_call_b64 s[36:37], L_iw
    s_add_u32 s53, s53, 1
    s_cmp_lt_u32 s53, 23
    s_cbranch_scc1 L_ld3
    s_waitcnt vmcnt(16)
    s_barrier
    s_call_b64 s[36:37], L_ix
    s_call_b64 s[36:37], L_iw
    s_getpc_b64 s[28:29]
L_pc2:
    s_lshl_b32 s24, s38, 12
    s_add_u32 s24, s24, L_tail-L_pc2
    v_lshl_add_u32 v13, v0, 6, s24
    v_min_u32 v13, L_end-L_pc2, v13
    global_load_dword v15, v13, s[28:29]
    s_mov_b32 s24, 0xffff0000
    s_mov_b32 s25, 0x3727c5ac
    s_mov_b32 s26, 0xbfb8aa3b
    v_lshlrev_b32 v20, 16, v17
    v_lshlrev_b32 v21, 16, v18
    v_lshlrev_b32 v22, 16, v16
    v_lshlrev_b32 v23, 16, v19
    v_add_f32 v20, s25, v20
    v_cvt_pk_bf16_f32 v20, v20, v20
    v_and_b32 v20, s24, v20
    v_sqrt_f32 v20, v20
    s_nop 0
    v_cvt_pk_bf16_f32 v20, v20, v20
    v_and_b32 v20, s24, v20
    v_rcp_f32 v20, v20
    s_nop 0
    v_cvt_pk_bf16_f32 v20, v20, v20
    v_and_b32 v20, s24, v20
    v_mul_f32 v20, v21, v20
    v_cvt_pk_bf16_f32 v20, v20, v20
    v_and_b32 v20, s24, v20
    v_fma_f32 v23, -v22, v20, v23
    v_mul_f32 v24, s26, v20
    v_mul_f32 v26, s26, v23
    v_and_b32 v20, s24, v17
    v_and_b32 v21, s24, v18
    v_and_b32 v22, s24, v16
    v_and_b32 v23, s24, v19
    v_add_f32 v20, s25, v20
    v_cvt_pk_bf16_f32 v20, v20, v20
    v_and_b32 v20, s24, v20
    v_sqrt_f32 v20, v20
    s_nop 0
    v_cvt_pk_bf16_f32 v20, v20, v20
    v_and_b32 v20, s24, v20
    v_rcp_f32 v20, v20
    s_nop 0
    v_cvt_pk_bf16_f32 v20, v20, v20
    v_and_b32 v20, s24, v20
    v_mul_f32 v20, v21, v20
    v_cvt_pk_bf16_f32 v20, v20, v20
    v_and_b32 v20, s24, v20
    v_fma_f32 v23, -v22, v20, v23
    v_mul_f32 v25, s26, v20
    v_mul_f32 v27, s26, v23
    s_lshl_b32 s27, s2, 10
    s_add_u32 s27, s27, 1048576
    v_lshl_add_u32 v12, v0, 3, s27
    global_store_dwordx2 v12, v[24:25], s[34:35] sc1
    global_store_dwordx2 v12, v[26:27], s[34:35] offset:512 sc1
    s_waitcnt vmcnt(16)
    s_barrier
    s_call_b64 s[36:37], L_ix
    s_call_b64 s[36:37], L_ix
    s_call_b64 s[36:37], L_iw
    s_waitcnt vmcnt(14)
    s_barrier
    s_call_b64 s[36:37], L_iw
    s_waitcnt vmcnt(6)
    s_barrier
    s_waitcnt vmcnt(0)
    s_barrier
    s_endpgm
L_compute:
    s_load_dwordx2 s[32:33], s[0:1], 48
    s_load_dwordx2 s[34:35], s[0:1], 64
    v_lshrrev_b32 v1, 4, v0
    v_and_b32 v3, 15, v0
    s_and_b32 s57, s38, 1
    s_lshr_b32 s58, s38, 1
    v_mov_b32 v8, 0
    v_mov_b32 v9, 0
    v_mov_b32 v10, 0
    v_mov_b32 v11, 0
    s_lshl_b32 s37, s58, 7
    s_add_u32 s36, s17, s37
    s_lshl_b32 s37, s57, 18
    s_add_u32 s36, s36, s37
    v_mfma_f32_32x32x16_bf16 v[128:143], v[8:11], v[8:11], 0
    v_mfma_f32_32x32x16_bf16 v[144:159], v[8:11], v[8:11], 0
    v_mfma_f32_32x32x16_bf16 v[160:175], v[8:11], v[8:11], 0
    v_mfma_f32_32x32x16_bf16 v[176:191], v[8:11], v[8:11], 0
    v_mfma_f32_32x32x16_bf16 v[192:207], v[8:11], v[8:11], 0
    v_mfma_f32_32x32x16_bf16 v[208:223], v[8:11], v[8:11], 0
    v_mfma_f32_32x32x16_bf16 v[224:239], v[8:11], v[8:11], 0
    v_mfma_f32_32x32x16_bf16 v[240:255], v[8:11], v[8:11], 0
    v_lshlrev_b32 v4, 14, v3
    v_add_u32 v4, s36, v4
    v_and_b32 v5, 1, v1
    v_lshl_add_u32 v4, v5, 5, v4
    v_lshrrev_b32 v5, 1, v1
    v_lshl_add_u32 v95, v5, 4, v4
    v_lshrrev_b32 v4, 1, v3
    v_xor_b32 v4, v4, v1
    v_lshlrev_b32 v4, 4, v4
    v_lshl_add_u32 v4, v3, 7, v4
    s_lshl_b32 s36, s57, 11
    v_add_u32 v88, s36, v4
    v_xor_b32 v89, 64, v88
    v_bfe_u32 v4, v0, 2, 2
    v_lshl_add_u32 v5, v1, 3, v4
    v_lshlrev_b32 v5, 8, v5
    v_and_b32 v6, 1, v1
    v_lshl_or_b32 v4, v4, 1, v6
    s_lshl_b32 s37, s58, 2
    v_xor_b32 v4, s37, v4
    v_lshl_add_u32 v5, v4, 5, v5
    v_and_b32 v4, 3, v0
    v_lshl_add_u32 v5, v4, 3, v5
    v_add_u32 v94, 65536, v5
    v_mov_b32 v90, v94
    v_xor_b32 v91, 32, v94
    v_xor_b32 v92, 64, v94
    v_xor_b32 v93, 96, v94
    s_lshl_b32 s59, s58, 8
    s_lshl_b32 s37, s2, 10
    s_add_u32 s59, s59, s37
    s_add_u32 s59, s59, 1048576
    v_lshl_add_u32 v124, v1, 4, s59
    v_bfe_u32 v4, v0, 2, 1
    v_bfe_u32 v5, v0, 1, 1
    v_and_b32 v6, 1, v0
    v_lshl_add_u32 v4, v4, 9, v124
    v_lshl_add_u32 v4, v5, 6, v4
    v_lshl_add_u32 v125, v6, 3, v4
    s_mov_b32 s14, 524288
    s_mov_b32 s15, 0x20000
    s_mov_b32 s50, 0
    s_mov_b32 s53, 0
    s_mov_b32 s46, 0xbfb8aa3b
    s_mov_b32 s47, s46
    s_movk_i32 s24, 0
    s_movk_i32 s25, 4096
    s_movk_i32 s26, 8192
    s_movk_i32 s27, 12288
    s_waitcnt lgkmcnt(0)
    s_add_u32 s12, s32, s39
    s_addc_u32 s13, s33, 0
    s_barrier
    ds_read_b64_tr_b16 v[68:69], v90 offset:8192
    ds_read_b64_tr_b16 v[70:71], v90 offset:9216
    ds_read_b128 v[0:3], v88 offset:0
    ds_read_b128 v[4:7], v88 offset:4096
    ds_read_b128 v[8:11], v88 offset:8192
    ds_read_b64_tr_b16 v[72:73], v90 offset:16384
    ds_read_b64_tr_b16 v[74:75], v90 offset:17408
    ds_read_b64_tr_b16 v[64:65], v90 offset:0
    ds_read_b64_tr_b16 v[66:67], v90 offset:1024
    ds_read_b128 v[12:15], v88 offset:12288
    s_waitcnt lgkmcnt(7)
    v_mfma_f32_16x16x32_bf16 v[128:131], v[68:71], v[0:3], v[128:131]
    ds_read_b64_tr_b16 v[80:81], v91 offset:8192
    s_waitcnt lgkmcnt(4)
    v_mfma_f32_16x16x32_bf16 v[128:131], v[72:75], v[4:7], v[128:131]
    ds_read_b64_tr_b16 v[82:83], v91 offset:9216
    v_mfma_f32_16x16x32_bf16 v[144:147], v[72:75], v[8:11], v[144:147]
    ds_read_b64_tr_b16 v[84:85], v91 offset:16384
    v_mfma_f32_16x16x32_bf16 v[144:147], v[68:71], v[4:7], v[144:147]
    ds_read_b64_tr_b16 v[86:87], v91 offset:17408
    s_waitcnt lgkmcnt(5)
    v_mfma_f32_16x16x32_bf16 v[144:147], v[64:67], v[0:3], v[144:147]
    ds_read_b64_tr_b16 v[76:77], v91 offset:0
    v_mfma_f32_16x16x32_bf16 v[160:163], v[64:67], v[4:7], v[160:163]
    ds_read_b64_tr_b16 v[78:79], v91 offset:1024
    v_mfma_f32_16x16x32_bf16 v[160:163], v[68:71], v[8:11], v[160:163]
    s_barrier
    s_waitcnt lgkmcnt(6)
    v_mfma_f32_16x16x32_bf16 v[160:163], v[72:75], v[12:15], v[160:163]
    ds_read_b128 v[16:19], v88 offset:16384
    s_waitcnt lgkmcnt(0)
    v_mfma_f32_16x16x32_bf16 v[176:179], v[72:75], v[16:19], v[176:179]
    ds_read_b128 v[20:23], v88 offset:20480
    v_mfma_f32_16x16x32_bf16 v[176:179], v[68:71], v[12:15], v[176:179]
    ds_read_b128 v[24:27], v88 offset:24576
    v_mfma_f32_16x16x32_bf16 v[176:179], v[64:67], v[8:11], v[176:179]
    ds_read_b128 v[28:31], v88 offset:28672
    v_mfma_f32_16x16x32_bf16 v[192:195], v[64:67], v[12:15], v[192:195]
    ds_read_b128 v[32:35], v89 offset:0
    v_mfma_f32_16x16x32_bf16 v[192:195], v[68:71], v[16:19], v[192:195]
    ds_read_b128 v[36:39], v89 offset:4096
    s_waitcnt lgkmcnt(4)
    v_mfma_f32_16x16x32_bf16 v[192:195], v[72:75], v[20:23], v[192:195]
    ds_read_b128 v[40:43], v89 offset:8192
    s_waitcnt lgkmcnt(4)
    v_mfma_f32_16x16x32_bf16 v[208:211], v[72:75], v[24:27], v[208:211]
    ds_read_b128 v[44:47], v89 offset:12288
    v_mfma_f32_16x16x32_bf16 v[208:211], v[68:71], v[20:23], v[208:211]
    ds_read_b128 v[48:51], v89 offset:16384
    v_mfma_f32_16x16x32_bf16 v[208:211], v[64:67], v[16:19], v[208:211]
    ds_read_b128 v[52:55], v89 offset:20480
    v_mfma_f32_16x16x32_bf16 v[224:227], v[64:67], v[20:23], v[224:227]
    ds_read_b128 v[56:59], v89 offset:24576
    v_mfma_f32_16x16x32_bf16 v[224:227], v[68:71], v[24:27], v[224:227]
    ds_read_b128 v[60:63], v89 offset:28672
    s_waitcnt lgkmcnt(8)
    v_mfma_f32_16x16x32_bf16 v[224:227], v[72:75], v[28:31], v[224:227]
    s_add_u32 s50, s50, 24576
    v_mfma_f32_16x16x32_bf16 v[240:243], v[68:71], v[28:31], v[240:243]
    s_cmp_eq_u32 s50, 98304
    v_mfma_f32_16x16x32_bf16 v[240:243], v[64:67], v[24:27], v[240:243]
    s_cselect_b32 s50, 0, s50
    s_branch L_g1
    .p2align 3
L_loop:
    s_waitcnt lgkmcnt(2)
    v_mfma_f32_16x16x32_bf16 v[128:131], v[68:71], v[0:3], v[128:131]
    ds_read_b64_tr_b16 v[80:81], v91 offset:8192
    v_mfma_f32_16x16x32_bf16 v[128:131], v[72:75], v[4:7], v[128:131]
    ds_read_b64_tr_b16 v[82:83], v91 offset:9216
    v_mfma_f32_16x16x32_bf16 v[144:147], v[72:75], v[8:11], v[144:147]
    ds_read_b64_tr_b16 v[84:85], v91 offset:16384
    v_mfma_f32_16x16x32_bf16 v[144:147], v[68:71], v[4:7], v[144:147]
    ds_read_b64_tr_b16 v[86:87], v91 offset:17408
    v_mfma_f32_16x16x32_bf16 v[144:147], v[64:67], v[0:3], v[144:147]
    ds_read_b64_tr_b16 v[76:77], v91 offset:0
    v_mfma_f32_16x16x32_bf16 v[160:163], v[64:67], v[4:7], v[160:163]
    ds_read_b64_tr_b16 v[78:79], v91 offset:1024
    v_mfma_f32_16x16x32_bf16 v[160:163], v[68:71], v[8:11], v[160:163]
    ds_read_b128 v[32:35], v89 offset:0
    v_mfma_f32_16x16x32_bf16 v[160:163], v[72:75], v[12:15], v[160:163]
    ds_read_b128 v[36:39], v89 offset:4096
    v_mfma_f32_16x16x32_bf16 v[176:179], v[72:75], v[16:19], v[176:179]
    ds_read_b128 v[40:43], v89 offset:8192
    v_mfma_f32_16x16x32_bf16 v[176:179], v[68:71], v[12:15], v[176:179]
    ds_read_b128 v[44:47], v89 offset:12288
    v_mfma_f32_16x16x32_bf16 v[176:179], v[64:67], v[8:11], v[176:179]
    ds_read_b128 v[48:51], v89 offset:16384
    v_mfma_f32_16x16x32_bf16 v[192:195], v[64:67], v[12:15], v[192:195]
    ds_read_b128 v[52:55], v89 offset:20480
    v_mfma_f32_16x16x32_bf16 v[192:195], v[68:71], v[16:19], v[192:195]
    ds_read_b128 v[56:59], v89 offset:24576
    v_mfma_f32_16x16x32_bf16 v[192:195], v[72:75], v[20:23], v[192:195]
    ds_read_b128 v[60:63], v89 offset:28672
    s_waitcnt lgkmcnt(10)
    v_mfma_f32_16x16x32_bf16 v[208:211], v[72:75], v[24:27], v[208:211]
    s_add_u32 s50, s50, 24576
    v_mfma_f32_16x16x32_bf16 v[208:211], v[68:71], v[20:23], v[208:211]
    s_cmp_eq_u32 s50, 98304
    v_mfma_f32_16x16x32_bf16 v[208:211], v[64:67], v[16:19], v[208:211]
    s_cselect_b32 s50, 0, s50
    v_mfma_f32_16x16x32_bf16 v[224:227], v[64:67], v[20:23], v[224:227]
    v_mfma_f32_16x16x32_bf16 v[224:227], v[68:71], v[24:27], v[224:227]
    v_mfma_f32_16x16x32_bf16 v[224:227], v[72:75], v[28:31], v[224:227]
    v_mfma_f32_16x16x32_bf16 v[240:243], v[68:71], v[28:31], v[240:243]
    v_mfma_f32_16x16x32_bf16 v[240:243], v[64:67], v[24:27], v[240:243]
L_g1:
    v_mfma_f32_16x16x32_bf16 v[132:135], v[80:83], v[0:3], v[132:135]
    ds_read_b64_tr_b16 v[68:69], v92 offset:8192
    v_mfma_f32_16x16x32_bf16 v[132:135], v[84:87], v[4:7], v[132:135]
    ds_read_b64_tr_b16 v[70:71], v92 offset:9216
    v_mfma_f32_16x16x32_bf16 v[148:151], v[84:87], v[8:11], v[148:151]
    ds_read_b64_tr_b16 v[72:73], v92 offset:16384
    v_mfma_f32_16x16x32_bf16 v[148:151], v[80:83], v[4:7], v[148:151]
    ds_read_b64_tr_b16 v[74:75], v92 offset:17408
    s_waitcnt lgkmcnt(4)
    v_mfma_f32_16x16x32_bf16 v[148:151], v[76:79], v[0:3], v[148:151]
    ds_read_b64_tr_b16 v[64:65], v92 offset:0
    v_mfma_f32_16x16x32_bf16 v[164:167], v[76:79], v[4:7], v[164:167]
    ds_read_b64_tr_b16 v[66:67], v92 offset:1024
    v_mfma_f32_16x16x32_bf16 v[164:167], v[80:83], v[8:11], v[164:167]
    v_add_u32 v90, s50, v94
    v_mfma_f32_16x16x32_bf16 v[164:167], v[84:87], v[12:15], v[164:167]
    v_xor_b32 v91, 32, v90
    v_mfma_f32_16x16x32_bf16 v[180:183], v[84:87], v[16:19], v[180:183]
    v_xor_b32 v89, 32768, v89
    v_mfma_f32_16x16x32_bf16 v[180:183], v[80:83], v[12:15], v[180:183]
    v_mfma_f32_16x16x32_bf16 v[180:183], v[76:79], v[8:11], v[180:183]
    v_mfma_f32_16x16x32_bf16 v[196:199], v[76:79], v[12:15], v[196:199]
    v_mfma_f32_16x16x32_bf16 v[196:199], v[80:83], v[16:19], v[196:199]
    v_mfma_f32_16x16x32_bf16 v[196:199], v[84:87], v[20:23], v[196:199]
    v_mfma_f32_16x16x32_bf16 v[212:215], v[84:87], v[24:27], v[212:215]
    v_mfma_f32_16x16x32_bf16 v[212:215], v[80:83], v[20:23], v[212:215]
    v_mfma_f32_16x16x32_bf16 v[212:215], v[76:79], v[16:19], v[212:215]
    v_mfma_f32_16x16x32_bf16 v[228:231], v[76:79], v[20:23], v[228:231]
    v_mfma_f32_16x16x32_bf16 v[228:231], v[80:83], v[24:27], v[228:231]
    v_mfma_f32_16x16x32_bf16 v[228:231], v[84:87], v[28:31], v[228:231]
    v_mfma_f32_16x16x32_bf16 v[244:247], v[80:83], v[28:31], v[244:247]
    v_mfma_f32_16x16x32_bf16 v[244:247], v[76:79], v[24:27], v[244:247]
    s_waitcnt lgkmcnt(0)
    v_mfma_f32_16x16x32_bf16 v[136:139], v[68:71], v[0:3], v[136:139]
    ds_read_b64_tr_b16 v[80:81], v93 offset:8192
    v_mfma_f32_16x16x32_bf16 v[136:139], v[72:75], v[4:7], v[136:139]
    ds_read_b64_tr_b16 v[82:83], v93 offset:9216
    v_mfma_f32_16x16x32_bf16 v[152:155], v[72:75], v[8:11], v[152:155]
    ds_read_b64_tr_b16 v[84:85], v93 offset:16384
    v_mfma_f32_16x16x32_bf16 v[152:155], v[68:71], v[4:7], v[152:155]
    ds_read_b64_tr_b16 v[86:87], v93 offset:17408
    v_mfma_f32_16x16x32_bf16 v[152:155], v[64:67], v[0:3], v[152:155]
    ds_read_b64_tr_b16 v[76:77], v93 offset:0
    v_mfma_f32_16x16x32_bf16 v[168:171], v[64:67], v[4:7], v[168:171]
    ds_read_b64_tr_b16 v[78:79], v93 offset:1024
    v_mfma_f32_16x16x32_bf16 v[168:171], v[68:71], v[8:11], v[168:171]
    v_xor_b32 v92, 64, v90
    v_mfma_f32_16x16x32_bf16 v[168:171], v[72:75], v[12:15], v[168:171]
    v_mfma_f32_16x16x32_bf16 v[184:187], v[72:75], v[16:19], v[184:187]
    v_mfma_f32_16x16x32_bf16 v[184:187], v[68:71], v[12:15], v[184:187]
    v_mfma_f32_16x16x32_bf16 v[184:187], v[64:67], v[8:11], v[184:187]
    v_mfma_f32_16x16x32_bf16 v[200:203], v[64:67], v[12:15], v[200:203]
    v_mfma_f32_16x16x32_bf16 v[200:203], v[68:71], v[16:19], v[200:203]
    v_mfma_f32_16x16x32_bf16 v[200:203], v[72:75], v[20:23], v[200:203]
    v_mfma_f32_16x16x32_bf16 v[216:219], v[72:75], v[24:27], v[216:219]
    v_mfma_f32_16x16x32_bf16 v[216:219], v[68:71], v[20:23], v[216:219]
    v_mfma_f32_16x16x32_bf16 v[216:219], v[64:67], v[16:19], v[216:219]
    v_mfma_f32_16x16x32_bf16 v[232:235], v[64:67], v[20:23], v[232:235]
    v_mfma_f32_16x16x32_bf16 v[232:235], v[68:71], v[24:27], v[232:235]
    v_mfma_f32_16x16x32_bf16 v[232:235], v[72:75], v[28:31], v[232:235]
    v_mfma_f32_16x16x32_bf16 v[248:251], v[68:71], v[28:31], v[248:251]
    v_mfma_f32_16x16x32_bf16 v[248:251], v[64:67], v[24:27], v[248:251]
    s_waitcnt lgkmcnt(0)
    s_barrier
    v_mfma_f32_16x16x32_bf16 v[140:143], v[80:83], v[0:3], v[140:143]
    ds_read_b64_tr_b16 v[68:69], v90 offset:8192
    v_mfma_f32_16x16x32_bf16 v[140:143], v[84:87], v[4:7], v[140:143]
    ds_read_b64_tr_b16 v[70:71], v90 offset:9216
    v_mfma_f32_16x16x32_bf16 v[156:159], v[84:87], v[8:11], v[156:159]
    ds_read_b64_tr_b16 v[72:73], v90 offset:16384
    v_mfma_f32_16x16x32_bf16 v[156:159], v[80:83], v[4:7], v[156:159]
    ds_read_b64_tr_b16 v[74:75], v90 offset:17408
    v_mfma_f32_16x16x32_bf16 v[156:159], v[76:79], v[0:3], v[156:159]
    ds_read_b64_tr_b16 v[64:65], v90 offset:0
    v_mfma_f32_16x16x32_bf16 v[172:175], v[76:79], v[4:7], v[172:175]
    ds_read_b64_tr_b16 v[66:67], v90 offset:1024
    v_mfma_f32_16x16x32_bf16 v[172:175], v[80:83], v[8:11], v[172:175]
    v_xor_b32 v93, 96, v90
    v_mfma_f32_16x16x32_bf16 v[172:175], v[84:87], v[12:15], v[172:175]
    v_mfma_f32_16x16x32_bf16 v[188:191], v[84:87], v[16:19], v[188:191]
    v_mfma_f32_16x16x32_bf16 v[188:191], v[80:83], v[12:15], v[188:191]
    v_mfma_f32_16x16x32_bf16 v[188:191], v[76:79], v[8:11], v[188:191]
    v_mfma_f32_16x16x32_bf16 v[204:207], v[76:79], v[12:15], v[204:207]
    v_mfma_f32_16x16x32_bf16 v[204:207], v[80:83], v[16:19], v[204:207]
    v_mfma_f32_16x16x32_bf16 v[204:207], v[84:87], v[20:23], v[204:207]
    v_mfma_f32_16x16x32_bf16 v[220:223], v[84:87], v[24:27], v[220:223]
    v_mfma_f32_16x16x32_bf16 v[220:223], v[80:83], v[20:23], v[220:223]
    v_mfma_f32_16x16x32_bf16 v[220:223], v[76:79], v[16:19], v[220:223]
    v_mfma_f32_16x16x32_bf16 v[236:239], v[76:79], v[20:23], v[236:239]
    v_mfma_f32_16x16x32_bf16 v[236:239], v[80:83], v[24:27], v[236:239]
    v_mfma_f32_16x16x32_bf16 v[236:239], v[84:87], v[28:31], v[236:239]
    v_mfma_f32_16x16x32_bf16 v[252:255], v[80:83], v[28:31], v[252:255]
    v_mfma_f32_16x16x32_bf16 v[252:255], v[76:79], v[24:27], v[252:255]
    s_waitcnt lgkmcnt(0)
    v_mfma_f32_16x16x32_bf16 v[128:131], v[68:71], v[32:35], v[128:131]
    ds_read_b64_tr_b16 v[80:81], v91 offset:8192
    v_mfma_f32_16x16x32_bf16 v[128:131], v[72:75], v[36:39], v[128:131]
    ds_read_b64_tr_b16 v[82:83], v91 offset:9216
    v_mfma_f32_16x16x32_bf16 v[144:147], v[72:75], v[40:43], v[144:147]
    ds_read_b64_tr_b16 v[84:85], v91 offset:16384
    v_mfma_f32_16x16x32_bf16 v[144:147], v[68:71], v[36:39], v[144:147]
    ds_read_b64_tr_b16 v[86:87], v91 offset:17408
    v_mfma_f32_16x16x32_bf16 v[144:147], v[64:67], v[32:35], v[144:147]
    ds_read_b64_tr_b16 v[76:77], v91 offset:0
    v_mfma_f32_16x16x32_bf16 v[160:163], v[64:67], v[36:39], v[160:163]
    ds_read_b64_tr_b16 v[78:79], v91 offset:1024
    v_mfma_f32_16x16x32_bf16 v[160:163], v[68:71], v[40:43], v[160:163]
    s_add_u32 s50, s50, 24576
    v_mfma_f32_16x16x32_bf16 v[160:163], v[72:75], v[44:47], v[160:163]
    s_cmp_eq_u32 s50, 98304
    v_mfma_f32_16x16x32_bf16 v[176:179], v[72:75], v[48:51], v[176:179]
    s_cselect_b32 s50, 0, s50
    v_mfma_f32_16x16x32_bf16 v[176:179], v[68:71], v[44:47], v[176:179]
    v_mfma_f32_16x16x32_bf16 v[176:179], v[64:67], v[40:43], v[176:179]
    v_mfma_f32_16x16x32_bf16 v[192:195], v[64:67], v[44:47], v[192:195]
    v_mfma_f32_16x16x32_bf16 v[192:195], v[68:71], v[48:51], v[192:195]
    v_mfma_f32_16x16x32_bf16 v[192:195], v[72:75], v[52:55], v[192:195]
    v_mfma_f32_16x16x32_bf16 v[208:211], v[72:75], v[56:59], v[208:211]
    v_mfma_f32_16x16x32_bf16 v[208:211], v[68:71], v[52:55], v[208:211]
    v_mfma_f32_16x16x32_bf16 v[208:211], v[64:67], v[48:51], v[208:211]
    v_mfma_f32_16x16x32_bf16 v[224:227], v[64:67], v[52:55], v[224:227]
    v_mfma_f32_16x16x32_bf16 v[224:227], v[68:71], v[56:59], v[224:227]
    v_mfma_f32_16x16x32_bf16 v[224:227], v[72:75], v[60:63], v[224:227]
    v_mfma_f32_16x16x32_bf16 v[240:243], v[68:71], v[60:63], v[240:243]
    v_mfma_f32_16x16x32_bf16 v[240:243], v[64:67], v[56:59], v[240:243]
    s_waitcnt lgkmcnt(0)
    v_mfma_f32_16x16x32_bf16 v[132:135], v[80:83], v[32:35], v[132:135]
    ds_read_b64_tr_b16 v[68:69], v92 offset:8192
    v_mfma_f32_16x16x32_bf16 v[132:135], v[84:87], v[36:39], v[132:135]
    ds_read_b64_tr_b16 v[70:71], v92 offset:9216
    v_mfma_f32_16x16x32_bf16 v[148:151], v[84:87], v[40:43], v[148:151]
    ds_read_b64_tr_b16 v[72:73], v92 offset:16384
    v_mfma_f32_16x16x32_bf16 v[148:151], v[80:83], v[36:39], v[148:151]
    ds_read_b64_tr_b16 v[74:75], v92 offset:17408
    v_mfma_f32_16x16x32_bf16 v[148:151], v[76:79], v[32:35], v[148:151]
    ds_read_b64_tr_b16 v[64:65], v92 offset:0
    v_mfma_f32_16x16x32_bf16 v[164:167], v[76:79], v[36:39], v[164:167]
    ds_read_b64_tr_b16 v[66:67], v92 offset:1024
    v_mfma_f32_16x16x32_bf16 v[164:167], v[80:83], v[40:43], v[164:167]
    v_add_u32 v90, s50, v94
    v_mfma_f32_16x16x32_bf16 v[164:167], v[84:87], v[44:47], v[164:167]
    v_xor_b32 v91, 32, v90
    v_mfma_f32_16x16x32_bf16 v[180:183], v[84:87], v[48:51], v[180:183]
    v_xor_b32 v88, 32768, v88
    v_mfma_f32_16x16x32_bf16 v[180:183], v[80:83], v[44:47], v[180:183]
    v_mfma_f32_16x16x32_bf16 v[180:183], v[76:79], v[40:43], v[180:183]
    v_mfma_f32_16x16x32_bf16 v[196:199], v[76:79], v[44:47], v[196:199]
    v_mfma_f32_16x16x32_bf16 v[196:199], v[80:83], v[48:51], v[196:199]
    v_mfma_f32_16x16x32_bf16 v[196:199], v[84:87], v[52:55], v[196:199]
    v_mfma_f32_16x16x32_bf16 v[212:215], v[84:87], v[56:59], v[212:215]
    v_mfma_f32_16x16x32_bf16 v[212:215], v[80:83], v[52:55], v[212:215]
    v_mfma_f32_16x16x32_bf16 v[212:215], v[76:79], v[48:51], v[212:215]
    v_mfma_f32_16x16x32_bf16 v[228:231], v[76:79], v[52:55], v[228:231]
    v_mfma_f32_16x16x32_bf16 v[228:231], v[80:83], v[56:59], v[228:231]
    v_mfma_f32_16x16x32_bf16 v[228:231], v[84:87], v[60:63], v[228:231]
    v_mfma_f32_16x16x32_bf16 v[244:247], v[80:83], v[60:63], v[244:247]
    v_mfma_f32_16x16x32_bf16 v[244:247], v[76:79], v[56:59], v[244:247]
    s_waitcnt lgkmcnt(0)
    v_mfma_f32_16x16x32_bf16 v[136:139], v[68:71], v[32:35], v[136:139]
    ds_read_b64_tr_b16 v[80:81], v93 offset:8192
    v_mfma_f32_16x16x32_bf16 v[136:139], v[72:75], v[36:39], v[136:139]
    ds_read_b64_tr_b16 v[82:83], v93 offset:9216
    v_mfma_f32_16x16x32_bf16 v[152:155], v[72:75], v[40:43], v[152:155]
    ds_read_b64_tr_b16 v[84:85], v93 offset:16384
    v_mfma_f32_16x16x32_bf16 v[152:155], v[68:71], v[36:39], v[152:155]
    ds_read_b64_tr_b16 v[86:87], v93 offset:17408
    v_mfma_f32_16x16x32_bf16 v[152:155], v[64:67], v[32:35], v[152:155]
    ds_read_b64_tr_b16 v[76:77], v93 offset:0
    v_mfma_f32_16x16x32_bf16 v[168:171], v[64:67], v[36:39], v[168:171]
    ds_read_b64_tr_b16 v[78:79], v93 offset:1024
    v_mfma_f32_16x16x32_bf16 v[168:171], v[68:71], v[40:43], v[168:171]
    v_xor_b32 v92, 64, v90
    v_mfma_f32_16x16x32_bf16 v[168:171], v[72:75], v[44:47], v[168:171]
    v_mfma_f32_16x16x32_bf16 v[184:187], v[72:75], v[48:51], v[184:187]
    v_mfma_f32_16x16x32_bf16 v[184:187], v[68:71], v[44:47], v[184:187]
    v_mfma_f32_16x16x32_bf16 v[184:187], v[64:67], v[40:43], v[184:187]
    v_mfma_f32_16x16x32_bf16 v[200:203], v[64:67], v[44:47], v[200:203]
    v_mfma_f32_16x16x32_bf16 v[200:203], v[68:71], v[48:51], v[200:203]
    v_mfma_f32_16x16x32_bf16 v[200:203], v[72:75], v[52:55], v[200:203]
    v_mfma_f32_16x16x32_bf16 v[216:219], v[72:75], v[56:59], v[216:219]
    v_mfma_f32_16x16x32_bf16 v[216:219], v[68:71], v[52:55], v[216:219]
    v_mfma_f32_16x16x32_bf16 v[216:219], v[64:67], v[48:51], v[216:219]
    v_mfma_f32_16x16x32_bf16 v[232:235], v[64:67], v[52:55], v[232:235]
    v_mfma_f32_16x16x32_bf16 v[232:235], v[68:71], v[56:59], v[232:235]
    v_mfma_f32_16x16x32_bf16 v[232:235], v[72:75], v[60:63], v[232:235]
    v_mfma_f32_16x16x32_bf16 v[248:251], v[68:71], v[60:63], v[248:251]
    v_mfma_f32_16x16x32_bf16 v[248:251], v[64:67], v[56:59], v[248:251]
    s_waitcnt lgkmcnt(0)
    s_barrier
    v_mfma_f32_16x16x32_bf16 v[140:143], v[80:83], v[32:35], v[140:143]
    ds_read_b64_tr_b16 v[68:69], v90 offset:8192
    v_mfma_f32_16x16x32_bf16 v[140:143], v[84:87], v[36:39], v[140:143]
    ds_read_b64_tr_b16 v[70:71], v90 offset:9216
    v_mfma_f32_16x16x32_bf16 v[156:159], v[84:87], v[40:43], v[156:159]
    ds_read_b128 v[0:3], v88 offset:0
    v_mfma_f32_16x16x32_bf16 v[156:159], v[80:83], v[36:39], v[156:159]
    ds_read_b128 v[4:7], v88 offset:4096
    v_mfma_f32_16x16x32_bf16 v[156:159], v[76:79], v[32:35], v[156:159]
    ds_read_b128 v[8:11], v88 offset:8192
    v_mfma_f32_16x16x32_bf16 v[172:175], v[76:79], v[36:39], v[172:175]
    ds_read_b64_tr_b16 v[72:73], v90 offset:16384
    v_mfma_f32_16x16x32_bf16 v[172:175], v[80:83], v[40:43], v[172:175]
    ds_read_b64_tr_b16 v[74:75], v90 offset:17408
    v_mfma_f32_16x16x32_bf16 v[172:175], v[84:87], v[44:47], v[172:175]
    ds_read_b64_tr_b16 v[64:65], v90 offset:0
    v_mfma_f32_16x16x32_bf16 v[188:191], v[84:87], v[48:51], v[188:191]
    ds_read_b64_tr_b16 v[66:67], v90 offset:1024
    v_mfma_f32_16x16x32_bf16 v[188:191], v[80:83], v[44:47], v[188:191]
    ds_read_b128 v[12:15], v88 offset:12288
    v_mfma_f32_16x16x32_bf16 v[188:191], v[76:79], v[40:43], v[188:191]
    ds_read_b128 v[16:19], v88 offset:16384
    v_mfma_f32_16x16x32_bf16 v[204:207], v[76:79], v[44:47], v[204:207]
    ds_read_b128 v[20:23], v88 offset:20480
    v_mfma_f32_16x16x32_bf16 v[204:207], v[80:83], v[48:51], v[204:207]
    ds_read_b128 v[24:27], v88 offset:24576
    v_mfma_f32_16x16x32_bf16 v[204:207], v[84:87], v[52:55], v[204:207]
    ds_read_b128 v[28:31], v88 offset:28672
    v_mfma_f32_16x16x32_bf16 v[220:223], v[84:87], v[56:59], v[220:223]
    v_xor_b32 v93, 96, v90
    v_mfma_f32_16x16x32_bf16 v[220:223], v[80:83], v[52:55], v[220:223]
    s_add_u32 s53, s53, 1
    v_mfma_f32_16x16x32_bf16 v[220:223], v[76:79], v[48:51], v[220:223]
    s_cmp_lt_u32 s53, 14
    v_mfma_f32_16x16x32_bf16 v[236:239], v[76:79], v[52:55], v[236:239]
    v_mfma_f32_16x16x32_bf16 v[236:239], v[80:83], v[56:59], v[236:239]
    v_mfma_f32_16x16x32_bf16 v[236:239], v[84:87], v[60:63], v[236:239]
    v_mfma_f32_16x16x32_bf16 v[252:255], v[80:83], v[60:63], v[252:255]
    v_mfma_f32_16x16x32_bf16 v[252:255], v[76:79], v[56:59], v[252:255]
    s_cbranch_scc1 L_loop
L_tail:
    s_waitcnt lgkmcnt(2)
    v_mfma_f32_16x16x32_bf16 v[128:131], v[68:71], v[0:3], v[128:131]
    ds_read_b64_tr_b16 v[80:81], v90 offset:32768
    v_mfma_f32_16x16x32_bf16 v[128:131], v[72:75], v[4:7], v[128:131]
    ds_read_b64_tr_b16 v[82:83], v90 offset:33792
    v_mfma_f32_16x16x32_bf16 v[144:147], v[72:75], v[8:11], v[144:147]
    ds_read_b128 v[32:35], v89 offset:0
    v_mfma_f32_16x16x32_bf16 v[144:147], v[68:71], v[4:7], v[144:147]
    ds_read_b128 v[36:39], v89 offset:4096
    v_mfma_f32_16x16x32_bf16 v[144:147], v[64:67], v[0:3], v[144:147]
    ds_read_b64_tr_b16 v[84:85], v90 offset:40960
    v_mfma_f32_16x16x32_bf16 v[160:163], v[64:67], v[4:7], v[160:163]
    ds_read_b64_tr_b16 v[86:87], v90 offset:41984
    v_mfma_f32_16x16x32_bf16 v[160:163], v[68:71], v[8:11], v[160:163]
    ds_read_b128 v[40:43], v89 offset:8192
    v_mfma_f32_16x16x32_bf16 v[160:163], v[72:75], v[12:15], v[160:163]
    ds_read_b64_tr_b16 v[76:77], v90 offset:24576
    v_mfma_f32_16x16x32_bf16 v[176:179], v[72:75], v[16:19], v[176:179]
    ds_read_b64_tr_b16 v[78:79], v90 offset:25600
    v_mfma_f32_16x16x32_bf16 v[176:179], v[68:71], v[12:15], v[176:179]
    ds_read_b128 v[44:47], v89 offset:12288
    v_mfma_f32_16x16x32_bf16 v[176:179], v[64:67], v[8:11], v[176:179]
    ds_read_b128 v[48:51], v89 offset:16384
    v_mfma_f32_16x16x32_bf16 v[192:195], v[64:67], v[12:15], v[192:195]
    ds_read_b128 v[52:55], v89 offset:20480
    v_mfma_f32_16x16x32_bf16 v[192:195], v[68:71], v[16:19], v[192:195]
    ds_read_b128 v[56:59], v89 offset:24576
    v_mfma_f32_16x16x32_bf16 v[192:195], v[72:75], v[20:23], v[192:195]
    ds_read_b128 v[60:63], v89 offset:28672
    s_waitcnt lgkmcnt(10)
    v_mfma_f32_16x16x32_bf16 v[208:211], v[72:75], v[24:27], v[208:211]
    v_add_u32 v94, 49152, v90
    v_mfma_f32_16x16x32_bf16 v[208:211], v[68:71], v[20:23], v[208:211]
    s_waitcnt vmcnt(0)
    v_mfma_f32_16x16x32_bf16 v[208:211], v[64:67], v[16:19], v[208:211]
    v_mfma_f32_16x16x32_bf16 v[224:227], v[64:67], v[20:23], v[224:227]
    v_mfma_f32_16x16x32_bf16 v[224:227], v[68:71], v[24:27], v[224:227]
    v_mfma_f32_16x16x32_bf16 v[224:227], v[72:75], v[28:31], v[224:227]
    v_mfma_f32_16x16x32_bf16 v[240:243], v[68:71], v[28:31], v[240:243]
    v_mfma_f32_16x16x32_bf16 v[240:243], v[64:67], v[24:27], v[240:243]
    v_mfma_f32_16x16x32_bf16 v[128:131], v[80:83], v[32:35], v[128:131]
    s_barrier
    s_waitcnt lgkmcnt(1)
    v_mfma_f32_16x16x32_bf16 v[128:131], v[84:87], v[36:39], v[128:131]
    ds_read_b64_tr_b16 v[68:69], v94 offset:8192
    v_mfma_f32_16x16x32_bf16 v[144:147], v[84:87], v[40:43], v[144:147]
    ds_read_b64_tr_b16 v[70:71], v94 offset:9216
    v_mfma_f32_16x16x32_bf16 v[144:147], v[80:83], v[36:39], v[144:147]
    ds_read_b128 v[0:3], v88 offset:32768
    v_mfma_f32_16x16x32_bf16 v[144:147], v[76:79], v[32:35], v[144:147]
    ds_read_b128 v[4:7], v88 offset:36864
    v_mfma_f32_16x16x32_bf16 v[160:163], v[76:79], v[36:39], v[160:163]
    ds_read_b64_tr_b16 v[72:73], v94 offset:16384
    v_mfma_f32_16x16x32_bf16 v[160:163], v[80:83], v[40:43], v[160:163]
    ds_read_b64_tr_b16 v[74:75], v94 offset:17408
    v_mfma_f32_16x16x32_bf16 v[160:163], v[84:87], v[44:47], v[160:163]
    ds_read_b128 v[8:11], v88 offset:40960
    v_mfma_f32_16x16x32_bf16 v[176:179], v[84:87], v[48:51], v[176:179]
    ds_read_b64_tr_b16 v[64:65], v94 offset:0
    v_mfma_f32_16x16x32_bf16 v[176:179], v[80:83], v[44:47], v[176:179]
    ds_read_b64_tr_b16 v[66:67], v94 offset:1024
    v_mfma_f32_16x16x32_bf16 v[176:179], v[76:79], v[40:43], v[176:179]
    ds_read_b128 v[12:15], v88 offset:45056
    v_mfma_f32_16x16x32_bf16 v[192:195], v[76:79], v[44:47], v[192:195]
    ds_read_b128 v[16:19], v88 offset:49152
    v_mfma_f32_16x16x32_bf16 v[192:195], v[80:83], v[48:51], v[192:195]
    ds_read_b128 v[20:23], v88 offset:53248
    v_mfma_f32_16x16x32_bf16 v[192:195], v[84:87], v[52:55], v[192:195]
    ds_read_b128 v[24:27], v88 offset:57344
    v_mfma_f32_16x16x32_bf16 v[208:211], v[84:87], v[56:59], v[208:211]
    ds_read_b128 v[28:31], v88 offset:61440
    v_mfma_f32_16x16x32_bf16 v[208:211], v[80:83], v[52:55], v[208:211]
    v_add_u32 v94, 73728, v90
    v_mfma_f32_16x16x32_bf16 v[208:211], v[76:79], v[48:51], v[208:211]
    global_load_dwordx4 v[96:99], v124, s[34:35] offset:0
    v_mfma_f32_16x16x32_bf16 v[224:227], v[76:79], v[52:55], v[224:227]
    global_load_dwordx4 v[112:115], v124, s[34:35] offset:512
    v_mfma_f32_16x16x32_bf16 v[224:227], v[80:83], v[56:59], v[224:227]
    global_load_dwordx4 v[100:103], v124, s[34:35] offset:64
    s_waitcnt lgkmcnt(6)
    v_mfma_f32_16x16x32_bf16 v[224:227], v[84:87], v[60:63], v[224:227]
    global_load_dwordx4 v[116:119], v124, s[34:35] offset:576
    v_mfma_f32_16x16x32_bf16 v[240:243], v[80:83], v[60:63], v[240:243]
    global_load_dwordx2 v[120:121], v125, s[34:35] offset:128
    v_mfma_f32_16x16x32_bf16 v[240:243], v[76:79], v[56:59], v[240:243]
    v_mfma_f32_16x16x32_bf16 v[128:131], v[68:71], v[0:3], v[128:131]
    s_barrier
    v_mfma_f32_16x16x32_bf16 v[128:131], v[72:75], v[4:7], v[128:131]
    ds_read_b64_tr_b16 v[80:81], v94 offset:8192
    v_mfma_f32_16x16x32_bf16 v[144:147], v[72:75], v[8:11], v[144:147]
    ds_read_b64_tr_b16 v[82:83], v94 offset:9216
    v_mfma_f32_16x16x32_bf16 v[144:147], v[68:71], v[4:7], v[144:147]
    ds_read_b128 v[32:35], v89 offset:32768
    s_waitcnt lgkmcnt(3)
    v_mfma_f32_16x16x32_bf16 v[144:147], v[64:67], v[0:3], v[144:147]
    ds_read_b128 v[36:39], v89 offset:36864
    v_mfma_f32_16x16x32_bf16 v[160:163], v[64:67], v[4:7], v[160:163]
    ds_read_b64_tr_b16 v[84:85], v94 offset:16384
    v_mfma_f32_16x16x32_bf16 v[160:163], v[68:71], v[8:11], v[160:163]
    ds_read_b64_tr_b16 v[86:87], v94 offset:17408
    v_mfma_f32_16x16x32_bf16 v[160:163], v[72:75], v[12:15], v[160:163]
    ds_read_b128 v[40:43], v89 offset:40960
    v_mfma_f32_16x16x32_bf16 v[176:179], v[72:75], v[16:19], v[176:179]
    ds_read_b64_tr_b16 v[76:77], v94 offset:0
    v_mfma_f32_16x16x32_bf16 v[176:179], v[68:71], v[12:15], v[176:179]
    ds_read_b64_tr_b16 v[78:79], v94 offset:1024
    v_mfma_f32_16x16x32_bf16 v[176:179], v[64:67], v[8:11], v[176:179]
    ds_read_b128 v[44:47], v89 offset:45056
    v_mfma_f32_16x16x32_bf16 v[192:195], v[64:67], v[12:15], v[192:195]
    ds_read_b128 v[48:51], v89 offset:49152
    v_mfma_f32_16x16x32_bf16 v[192:195], v[68:71], v[16:19], v[192:195]
    ds_read_b128 v[52:55], v89 offset:53248
    v_mfma_f32_16x16x32_bf16 v[192:195], v[72:75], v[20:23], v[192:195]
    ds_read_b128 v[56:59], v89 offset:57344
    v_mfma_f32_16x16x32_bf16 v[208:211], v[72:75], v[24:27], v[208:211]
    ds_read_b128 v[60:63], v89 offset:61440
    v_mfma_f32_16x16x32_bf16 v[208:211], v[68:71], v[20:23], v[208:211]
    v_add_u32 v94, 73728, v91
    v_mfma_f32_16x16x32_bf16 v[208:211], v[64:67], v[16:19], v[208:211]
    v_mfma_f32_16x16x32_bf16 v[224:227], v[64:67], v[20:23], v[224:227]
    v_mfma_f32_16x16x32_bf16 v[224:227], v[68:71], v[24:27], v[224:227]
    v_mfma_f32_16x16x32_bf16 v[224:227], v[72:75], v[28:31], v[224:227]
    v_mfma_f32_16x16x32_bf16 v[240:243], v[68:71], v[28:31], v[240:243]
    v_mfma_f32_16x16x32_bf16 v[240:243], v[64:67], v[24:27], v[240:243]
    s_waitcnt lgkmcnt(3)
    v_mfma_f32_16x16x32_bf16 v[128:131], v[80:83], v[32:35], v[128:131]
    ds_read_b64_tr_b16 v[68:69], v94 offset:8192
    v_mfma_f32_16x16x32_bf16 v[128:131], v[84:87], v[36:39], v[128:131]
    ds_read_b64_tr_b16 v[70:71], v94 offset:9216
    v_mfma_f32_16x16x32_bf16 v[144:147], v[84:87], v[40:43], v[144:147]
    ds_read_b64_tr_b16 v[72:73], v94 offset:16384
    v_mfma_f32_16x16x32_bf16 v[144:147], v[80:83], v[36:39], v[144:147]
    ds_read_b64_tr_b16 v[74:75], v94 offset:17408
    v_mfma_f32_16x16x32_bf16 v[144:147], v[76:79], v[32:35], v[144:147]
    ds_read_b64_tr_b16 v[64:65], v94 offset:0
    v_mfma_f32_16x16x32_bf16 v[160:163], v[76:79], v[36:39], v[160:163]
    ds_read_b64_tr_b16 v[66:67], v94 offset:1024
    v_mfma_f32_16x16x32_bf16 v[160:163], v[80:83], v[40:43], v[160:163]
    v_add_u32 v94, 49152, v91
    v_mfma_f32_16x16x32_bf16 v[160:163], v[84:87], v[44:47], v[160:163]
    v_mfma_f32_16x16x32_bf16 v[176:179], v[84:87], v[48:51], v[176:179]
    v_mfma_f32_16x16x32_bf16 v[176:179], v[80:83], v[44:47], v[176:179]
    v_mfma_f32_16x16x32_bf16 v[176:179], v[76:79], v[40:43], v[176:179]
    v_mfma_f32_16x16x32_bf16 v[192:195], v[76:79], v[44:47], v[192:195]
    v_mfma_f32_16x16x32_bf16 v[192:195], v[80:83], v[48:51], v[192:195]
    s_waitcnt lgkmcnt(3)
    v_mfma_f32_16x16x32_bf16 v[192:195], v[84:87], v[52:55], v[192:195]
    v_mfma_f32_16x16x32_bf16 v[208:211], v[84:87], v[56:59], v[208:211]
    v_mfma_f32_16x16x32_bf16 v[208:211], v[80:83], v[52:55], v[208:211]
    v_mfma_f32_16x16x32_bf16 v[208:211], v[76:79], v[48:51], v[208:211]
    v_mfma_f32_16x16x32_bf16 v[224:227], v[76:79], v[52:55], v[224:227]
    v_mfma_f32_16x16x32_bf16 v[224:227], v[80:83], v[56:59], v[224:227]
    v_mfma_f32_16x16x32_bf16 v[224:227], v[84:87], v[60:63], v[224:227]
    v_mfma_f32_16x16x32_bf16 v[240:243], v[80:83], v[60:63], v[240:243]
    v_mfma_f32_16x16x32_bf16 v[240:243], v[76:79], v[56:59], v[240:243]
    s_waitcnt vmcnt(0)
    v_mfma_f32_16x16x32_bf16 v[132:135], v[68:71], v[32:35], v[132:135]
    ds_read_b64_tr_b16 v[80:81], v94 offset:8192
    s_waitcnt lgkmcnt(1)
    v_mfma_f32_16x16x32_bf16 v[132:135], v[72:75], v[36:39], v[132:135]
    ds_read_b64_tr_b16 v[82:83], v94 offset:9216
    v_fma_f32 v128, v128, v96, v112
    v_mfma_f32_16x16x32_bf16 v[148:151], v[72:75], v[40:43], v[148:151]
    ds_read_b64_tr_b16 v[84:85], v94 offset:16384
    v_fma_f32 v129, v129, v97, v113
    v_mfma_f32_16x16x32_bf16 v[148:151], v[68:71], v[36:39], v[148:151]
    ds_read_b64_tr_b16 v[86:87], v94 offset:17408
    v_fma_f32 v130, v130, v98, v114
    v_mfma_f32_16x16x32_bf16 v[148:151], v[64:67], v[32:35], v[148:151]
    ds_read_b64_tr_b16 v[76:77], v94 offset:0
    v_fma_f32 v131, v131, v99, v115
    v_mfma_f32_16x16x32_bf16 v[164:167], v[64:67], v[36:39], v[164:167]
    v_exp_f32 v111, v128
    v_mfma_f32_16x16x32_bf16 v[164:167], v[68:71], v[40:43], v[164:167]
    v_exp_f32 v110, v129
    v_mfma_f32_16x16x32_bf16 v[164:167], v[72:75], v[44:47], v[164:167]
    v_exp_f32 v109, v130
    v_mfma_f32_16x16x32_bf16 v[180:183], v[72:75], v[48:51], v[180:183]
    v_exp_f32 v108, v131
    v_mfma_f32_16x16x32_bf16 v[180:183], v[68:71], v[44:47], v[180:183]
    ds_read_b64_tr_b16 v[78:79], v94 offset:1024
    v_fma_f32 v111, v111, s46, s46
    v_mfma_f32_16x16x32_bf16 v[180:183], v[64:67], v[40:43], v[180:183]
    v_fma_f32 v110, v110, s46, s46
    v_fma_f32 v109, v109, s46, s46
    v_mfma_f32_16x16x32_bf16 v[196:199], v[64:67], v[44:47], v[196:199]
    v_fma_f32 v108, v108, s46, s46
    v_fma_f32 v144, v144, v96, v112
    v_mfma_f32_16x16x32_bf16 v[196:199], v[68:71], v[48:51], v[196:199]
    v_rcp_f32 v111, v111
    v_mfma_f32_16x16x32_bf16 v[196:199], v[72:75], v[52:55], v[196:199]
    v_rcp_f32 v110, v110
    v_mfma_f32_16x16x32_bf16 v[212:215], v[72:75], v[56:59], v[212:215]
    v_rcp_f32 v109, v109
    v_mfma_f32_16x16x32_bf16 v[212:215], v[68:71], v[52:55], v[212:215]
    v_rcp_f32 v108, v108
    v_mfma_f32_16x16x32_bf16 v[212:215], v[64:67], v[48:51], v[212:215]
    v_mul_f32 v128, v128, v111
    v_mul_f32 v129, v129, v110
    v_mfma_f32_16x16x32_bf16 v[228:231], v[64:67], v[52:55], v[228:231]
    v_mul_f32 v130, v130, v109
    v_mul_f32 v131, v131, v108
    v_mfma_f32_16x16x32_bf16 v[228:231], v[68:71], v[56:59], v[228:231]
    v_cvt_pk_bf16_f32 v131, v130, v131
    v_cvt_pk_bf16_f32 v130, v128, v129
    v_mfma_f32_16x16x32_bf16 v[228:231], v[72:75], v[60:63], v[228:231]
    v_fma_f32 v145, v145, v97, v113
    v_fma_f32 v146, v146, v98, v114
    v_mfma_f32_16x16x32_bf16 v[244:247], v[68:71], v[60:63], v[244:247]
    v_fma_f32 v147, v147, v99, v115
    v_fma_f32 v160, v160, v96, v112
    v_mfma_f32_16x16x32_bf16 v[244:247], v[64:67], v[56:59], v[244:247]
    v_fma_f32 v161, v161, v97, v113
    s_waitcnt lgkmcnt(0)
    v_mfma_f32_16x16x32_bf16 v[132:135], v[80:83], v[0:3], v[132:135]
    v_exp_f32 v107, v144
    v_mfma_f32_16x16x32_bf16 v[132:135], v[84:87], v[4:7], v[132:135]
    v_exp_f32 v106, v145
    v_mfma_f32_16x16x32_bf16 v[148:151], v[84:87], v[8:11], v[148:151]
    v_exp_f32 v105, v146
    v_mfma_f32_16x16x32_bf16 v[148:151], v[80:83], v[4:7], v[148:151]
    v_exp_f32 v104, v147
    v_mfma_f32_16x16x32_bf16 v[148:151], v[76:79], v[0:3], v[148:151]
    ds_read_b64_tr_b16 v[68:69], v91 offset:32768
    v_fma_f32 v107, v107, s46, s46
    v_mfma_f32_16x16x32_bf16 v[164:167], v[76:79], v[4:7], v[164:167]
    ds_read_b64_tr_b16 v[70:71], v91 offset:33792
    v_fma_f32 v106, v106, s46, s46
    v_mfma_f32_16x16x32_bf16 v[164:167], v[80:83], v[8:11], v[164:167]
    ds_read_b128 v[32:35], v89 offset:0
    v_fma_f32 v105, v105, s46, s46
    v_mfma_f32_16x16x32_bf16 v[164:167], v[84:87], v[12:15], v[164:167]
    ds_read_b128 v[36:39], v89 offset:4096
    v_fma_f32 v104, v104, s46, s46
    v_mfma_f32_16x16x32_bf16 v[180:183], v[84:87], v[16:19], v[180:183]
    v_rcp_f32 v107, v107
    v_mfma_f32_16x16x32_bf16 v[180:183], v[80:83], v[12:15], v[180:183]
    v_rcp_f32 v106, v106
    v_mfma_f32_16x16x32_bf16 v[180:183], v[76:79], v[8:11], v[180:183]
    v_rcp_f32 v105, v105
    v_mfma_f32_16x16x32_bf16 v[196:199], v[76:79], v[12:15], v[196:199]
    v_rcp_f32 v104, v104
    v_mfma_f32_16x16x32_bf16 v[196:199], v[80:83], v[16:19], v[196:199]
    ds_read_b64_tr_b16 v[72:73], v91 offset:40960
    v_mul_f32 v144, v144, v107
    v_mfma_f32_16x16x32_bf16 v[196:199], v[84:87], v[20:23], v[196:199]
    ds_read_b64_tr_b16 v[74:75], v91 offset:41984
    v_mul_f32 v145, v145, v106
    v_mfma_f32_16x16x32_bf16 v[212:215], v[84:87], v[24:27], v[212:215]
    ds_read_b128 v[40:43], v89 offset:8192
    v_mul_f32 v146, v146, v105
    v_mfma_f32_16x16x32_bf16 v[212:215], v[80:83], v[20:23], v[212:215]
    ds_read_b64_tr_b16 v[64:65], v91 offset:24576
    v_mul_f32 v147, v147, v104
    v_mfma_f32_16x16x32_bf16 v[212:215], v[76:79], v[16:19], v[212:215]
    ds_read_b64_tr_b16 v[66:67], v91 offset:25600
    v_cvt_pk_bf16_f32 v147, v146, v147
    v_mfma_f32_16x16x32_bf16 v[228:231], v[76:79], v[20:23], v[228:231]
    ds_read_b128 v[44:47], v89 offset:12288
    v_cvt_pk_bf16_f32 v146, v144, v145
    v_mfma_f32_16x16x32_bf16 v[228:231], v[80:83], v[24:27], v[228:231]
    ds_read_b128 v[48:51], v89 offset:16384
    v_fma_f32 v162, v162, v98, v114
    v_mfma_f32_16x16x32_bf16 v[228:231], v[84:87], v[28:31], v[228:231]
    ds_read_b128 v[52:55], v89 offset:20480
    v_fma_f32 v163, v163, v99, v115
    v_mfma_f32_16x16x32_bf16 v[244:247], v[80:83], v[28:31], v[244:247]
    ds_read_b128 v[56:59], v89 offset:24576
    v_fma_f32 v176, v176, v96, v112
    v_mfma_f32_16x16x32_bf16 v[244:247], v[76:79], v[24:27], v[244:247]
    ds_read_b128 v[60:63], v89 offset:28672
    s_waitcnt lgkmcnt(10)
    v_mfma_f32_16x16x32_bf16 v[132:135], v[68:71], v[32:35], v[132:135]
    ds_read_b64_tr_b16 v[80:81], v91 offset:8192
    s_waitcnt lgkmcnt(9)
    v_mfma_f32_16x16x32_bf16 v[132:135], v[72:75], v[36:39], v[132:135]
    ds_read_b64_tr_b16 v[82:83], v91 offset:9216
    s_waitcnt lgkmcnt(9)
    v_mfma_f32_16x16x32_bf16 v[148:151], v[72:75], v[40:43], v[148:151]
    v_exp_f32 v111, v160
    v_mfma_f32_16x16x32_bf16 v[148:151], v[68:71], v[36:39], v[148:151]
    ds_read_b128 v[0:3], v88 offset:0
    s_waitcnt lgkmcnt(8)
    v_mfma_f32_16x16x32_bf16 v[148:151], v[64:67], v[32:35], v[148:151]
    v_exp_f32 v110, v161
    v_mfma_f32_16x16x32_bf16 v[164:167], v[64:67], v[36:39], v[164:167]
    v_exp_f32 v109, v162
    v_mfma_f32_16x16x32_bf16 v[164:167], v[68:71], v[40:43], v[164:167]
    ds_read_b128 v[4:7], v88 offset:4096
    s_waitcnt lgkmcnt(7)
    v_mfma_f32_16x16x32_bf16 v[164:167], v[72:75], v[44:47], v[164:167]
    v_exp_f32 v108, v163
    v_mfma_f32_16x16x32_bf16 v[180:183], v[72:75], v[48:51], v[180:183]
    ds_read_b64_tr_b16 v[84:85], v91 offset:16384
    v_fma_f32 v111, v111, s46, s46
    v_mfma_f32_16x16x32_bf16 v[180:183], v[68:71], v[44:47], v[180:183]
    ds_read_b64_tr_b16 v[86:87], v91 offset:17408
    v_fma_f32 v110, v110, s46, s46
    v_mfma_f32_16x16x32_bf16 v[180:183], v[64:67], v[40:43], v[180:183]
    ds_read_b128 v[8:11], v88 offset:8192
    v_fma_f32 v109, v109, s46, s46
    v_mfma_f32_16x16x32_bf16 v[196:199], v[64:67], v[44:47], v[196:199]
    ds_read_b64_tr_b16 v[76:77], v91 offset:0
    v_fma_f32 v108, v108, s46, s46
    v_mfma_f32_16x16x32_bf16 v[196:199], v[68:71], v[48:51], v[196:199]
    ds_read_b64_tr_b16 v[78:79], v91 offset:1024
    s_waitcnt lgkmcnt(7)
    v_mfma_f32_16x16x32_bf16 v[196:199], v[72:75], v[52:55], v[196:199]
    v_rcp_f32 v111, v111
    v_mfma_f32_16x16x32_bf16 v[212:215], v[72:75], v[56:59], v[212:215]
    v_rcp_f32 v110, v110
    v_mfma_f32_16x16x32_bf16 v[212:215], v[68:71], v[52:55], v[212:215]
    v_rcp_f32 v109, v109
    v_mfma_f32_16x16x32_bf16 v[212:215], v[64:67], v[48:51], v[212:215]
    v_rcp_f32 v108, v108
    v_mfma_f32_16x16x32_bf16 v[228:231], v[64:67], v[52:55], v[228:231]
    ds_read_b128 v[12:15], v88 offset:12288
    v_mul_f32 v160, v160, v111
    v_mfma_f32_16x16x32_bf16 v[228:231], v[68:71], v[56:59], v[228:231]
    ds_read_b128 v[16:19], v88 offset:16384
    v_mul_f32 v161, v161, v110
    v_mfma_f32_16x16x32_bf16 v[228:231], v[72:75], v[60:63], v[228:231]
    ds_read_b128 v[20:23], v88 offset:20480
    v_mul_f32 v162, v162, v109
    v_mfma_f32_16x16x32_bf16 v[244:247], v[68:71], v[60:63], v[244:247]
    ds_read_b128 v[24:27], v88 offset:24576
    v_mul_f32 v163, v163, v108
    v_mfma_f32_16x16x32_bf16 v[244:247], v[64:67], v[56:59], v[244:247]
    ds_read_b128 v[28:31], v88 offset:28672
    s_waitcnt lgkmcnt(6)
    v_mfma_f32_16x16x32_bf16 v[132:135], v[80:83], v[0:3], v[132:135]
    ds_read_b64_tr_b16 v[68:69], v92 offset:8192
    v_cvt_pk_bf16_f32 v163, v162, v163
    v_mfma_f32_16x16x32_bf16 v[132:135], v[84:87], v[4:7], v[132:135]
    ds_read_b64_tr_b16 v[70:71], v92 offset:9216
    v_cvt_pk_bf16_f32 v162, v160, v161
    v_mfma_f32_16x16x32_bf16 v[148:151], v[84:87], v[8:11], v[148:151]
    ds_read_b64_tr_b16 v[72:73], v92 offset:16384
    v_fma_f32 v177, v177, v97, v113
    v_mfma_f32_16x16x32_bf16 v[148:151], v[80:83], v[4:7], v[148:151]
    ds_read_b64_tr_b16 v[74:75], v92 offset:17408
    s_waitcnt lgkmcnt(9)
    v_mfma_f32_16x16x32_bf16 v[148:151], v[76:79], v[0:3], v[148:151]
    ds_read_b64_tr_b16 v[64:65], v92 offset:0
    v_fma_f32 v178, v178, v98, v114
    v_mfma_f32_16x16x32_bf16 v[164:167], v[76:79], v[4:7], v[164:167]
    ds_read_b64_tr_b16 v[66:67], v92 offset:1024
    v_fma_f32 v179, v179, v99, v115
    v_mfma_f32_16x16x32_bf16 v[164:167], v[80:83], v[8:11], v[164:167]
    v_fma_f32 v192, v192, v96, v112
    s_waitcnt lgkmcnt(9)
    v_mfma_f32_16x16x32_bf16 v[164:167], v[84:87], v[12:15], v[164:167]
    v_exp_f32 v107, v176
    v_mfma_f32_16x16x32_bf16 v[180:183], v[84:87], v[16:19], v[180:183]
    v_exp_f32 v106, v177
    v_mfma_f32_16x16x32_bf16 v[180:183], v[80:83], v[12:15], v[180:183]
    v_exp_f32 v105, v178
    v_mfma_f32_16x16x32_bf16 v[180:183], v[76:79], v[8:11], v[180:183]
    v_exp_f32 v104, v179
    v_mfma_f32_16x16x32_bf16 v[196:199], v[76:79], v[12:15], v[196:199]
    v_fma_f32 v107, v107, s46, s46
    v_fma_f32 v106, v106, s46, s46
    v_mfma_f32_16x16x32_bf16 v[196:199], v[80:83], v[16:19], v[196:199]
    v_fma_f32 v105, v105, s46, s46
    s_waitcnt lgkmcnt(3)
    v_mfma_f32_16x16x32_bf16 v[196:199], v[84:87], v[20:23], v[196:199]
    v_fma_f32 v104, v104, s46, s46
    v_fma_f32 v193, v193, v97, v113
    v_mfma_f32_16x16x32_bf16 v[212:215], v[84:87], v[24:27], v[212:215]
    v_rcp_f32 v107, v107
    v_mfma_f32_16x16x32_bf16 v[212:215], v[80:83], v[20:23], v[212:215]
    v_rcp_f32 v106, v106
    v_mfma_f32_16x16x32_bf16 v[212:215], v[76:79], v[16:19], v[212:215]
    v_rcp_f32 v105, v105
    v_mfma_f32_16x16x32_bf16 v[228:231], v[76:79], v[20:23], v[228:231]
    v_rcp_f32 v104, v104
    v_mfma_f32_16x16x32_bf16 v[228:231], v[80:83], v[24:27], v[228:231]
    v_mul_f32 v176, v176, v107
    v_mul_f32 v177, v177, v106
    v_mfma_f32_16x16x32_bf16 v[228:231], v[84:87], v[28:31], v[228:231]
    v_mul_f32 v178, v178, v105
    v_mul_f32 v179, v179, v104
    v_mfma_f32_16x16x32_bf16 v[244:247], v[80:83], v[28:31], v[244:247]
    v_cvt_pk_bf16_f32 v179, v178, v179
    v_cvt_pk_bf16_f32 v178, v176, v177
    v_mfma_f32_16x16x32_bf16 v[244:247], v[76:79], v[24:27], v[244:247]
    v_fma_f32 v194, v194, v98, v114
    v_mfma_f32_16x16x32_bf16 v[136:139], v[68:71], v[0:3], v[136:139]
    ds_read_b64_tr_b16 v[80:81], v93 offset:8192
    s_waitcnt lgkmcnt(1)
    v_mfma_f32_16x16x32_bf16 v[136:139], v[72:75], v[4:7], v[136:139]
    ds_read_b64_tr_b16 v[82:83], v93 offset:9216
    v_fma_f32 v195, v195, v99, v115
    v_mfma_f32_16x16x32_bf16 v[152:155], v[72:75], v[8:11], v[152:155]
    v_exp_f32 v111, v192
    v_mfma_f32_16x16x32_bf16 v[152:155], v[68:71], v[4:7], v[152:155]
    v_exp_f32 v110, v193
    v_mfma_f32_16x16x32_bf16 v[152:155], v[64:67], v[0:3], v[152:155]
    v_exp_f32 v109, v194
    v_mfma_f32_16x16x32_bf16 v[168:171], v[64:67], v[4:7], v[168:171]
    v_exp_f32 v108, v195
    v_mfma_f32_16x16x32_bf16 v[168:171], v[68:71], v[8:11], v[168:171]
    ds_read_b64_tr_b16 v[84:85], v93 offset:16384
    v_fma_f32 v111, v111, s46, s46
    v_mfma_f32_16x16x32_bf16 v[168:171], v[72:75], v[12:15], v[168:171]
    ds_read_b64_tr_b16 v[86:87], v93 offset:17408
    v_fma_f32 v110, v110, s46, s46
    v_mfma_f32_16x16x32_bf16 v[184:187], v[72:75], v[16:19], v[184:187]
    ds_read_b64_tr_b16 v[76:77], v93 offset:0
    v_fma_f32 v109, v109, s46, s46
    v_mfma_f32_16x16x32_bf16 v[184:187], v[68:71], v[12:15], v[184:187]
    ds_read_b64_tr_b16 v[78:79], v93 offset:1024
    v_fma_f32 v108, v108, s46, s46
    v_mfma_f32_16x16x32_bf16 v[184:187], v[64:67], v[8:11], v[184:187]
    v_rcp_f32 v111, v111
    v_mfma_f32_16x16x32_bf16 v[200:203], v[64:67], v[12:15], v[200:203]
    v_rcp_f32 v110, v110
    v_mfma_f32_16x16x32_bf16 v[200:203], v[68:71], v[16:19], v[200:203]
    v_rcp_f32 v109, v109
    v_mfma_f32_16x16x32_bf16 v[200:203], v[72:75], v[20:23], v[200:203]
    v_rcp_f32 v108, v108
    v_mfma_f32_16x16x32_bf16 v[216:219], v[72:75], v[24:27], v[216:219]
    v_mul_f32 v192, v192, v111
    v_mul_f32 v193, v193, v110
    v_mfma_f32_16x16x32_bf16 v[216:219], v[68:71], v[20:23], v[216:219]
    v_mul_f32 v194, v194, v109
    v_mul_f32 v195, v195, v108
    v_mfma_f32_16x16x32_bf16 v[216:219], v[64:67], v[16:19], v[216:219]
    v_cvt_pk_bf16_f32 v195, v194, v195
    v_cvt_pk_bf16_f32 v194, v192, v193
    v_mfma_f32_16x16x32_bf16 v[232:235], v[64:67], v[20:23], v[232:235]
    v_fma_f32 v208, v208, v96, v112
    v_fma_f32 v209, v209, v97, v113
    v_mfma_f32_16x16x32_bf16 v[232:235], v[68:71], v[24:27], v[232:235]
    v_fma_f32 v210, v210, v98, v114
    v_fma_f32 v211, v211, v99, v115
    v_mfma_f32_16x16x32_bf16 v[232:235], v[72:75], v[28:31], v[232:235]
    v_exp_f32 v107, v208
    v_mfma_f32_16x16x32_bf16 v[248:251], v[68:71], v[28:31], v[248:251]
    v_exp_f32 v106, v209
    v_mfma_f32_16x16x32_bf16 v[248:251], v[64:67], v[24:27], v[248:251]
    v_fma_f32 v132, v132, v100, v116
    s_waitcnt lgkmcnt(0)
    v_mfma_f32_16x16x32_bf16 v[140:143], v[80:83], v[0:3], v[140:143]
    v_exp_f32 v105, v210
    v_mfma_f32_16x16x32_bf16 v[140:143], v[84:87], v[4:7], v[140:143]
    v_exp_f32 v104, v211
    v_mfma_f32_16x16x32_bf16 v[156:159], v[84:87], v[8:11], v[156:159]
    ds_read_b64_tr_b16 v[68:69], v92 offset:32768
    v_fma_f32 v107, v107, s46, s46
    v_mfma_f32_16x16x32_bf16 v[156:159], v[80:83], v[4:7], v[156:159]
    ds_read_b64_tr_b16 v[70:71], v92 offset:33792
    v_fma_f32 v106, v106, s46, s46
    v_mfma_f32_16x16x32_bf16 v[156:159], v[76:79], v[0:3], v[156:159]
    ds_read_b64_tr_b16 v[72:73], v92 offset:40960
    v_fma_f32 v105, v105, s46, s46
    v_mfma_f32_16x16x32_bf16 v[172:175], v[76:79], v[4:7], v[172:175]
    ds_read_b64_tr_b16 v[74:75], v92 offset:41984
    v_fma_f32 v104, v104, s46, s46
    v_mfma_f32_16x16x32_bf16 v[172:175], v[80:83], v[8:11], v[172:175]
    v_rcp_f32 v107, v107
    v_mfma_f32_16x16x32_bf16 v[172:175], v[84:87], v[12:15], v[172:175]
    v_rcp_f32 v106, v106
    v_mfma_f32_16x16x32_bf16 v[188:191], v[84:87], v[16:19], v[188:191]
    v_rcp_f32 v105, v105
    v_mfma_f32_16x16x32_bf16 v[188:191], v[80:83], v[12:15], v[188:191]
    v_rcp_f32 v104, v104
    v_mfma_f32_16x16x32_bf16 v[188:191], v[76:79], v[8:11], v[188:191]
    ds_read_b64_tr_b16 v[64:65], v92 offset:24576
    v_mul_f32 v208, v208, v107
    v_mfma_f32_16x16x32_bf16 v[204:207], v[76:79], v[12:15], v[204:207]
    ds_read_b64_tr_b16 v[66:67], v92 offset:25600
    v_mul_f32 v209, v209, v106
    v_mfma_f32_16x16x32_bf16 v[204:207], v[80:83], v[16:19], v[204:207]
    v_mul_f32 v210, v210, v105
    v_mul_f32 v211, v211, v104
    v_mfma_f32_16x16x32_bf16 v[204:207], v[84:87], v[20:23], v[204:207]
    v_cvt_pk_bf16_f32 v211, v210, v211
    v_cvt_pk_bf16_f32 v210, v208, v209
    v_mfma_f32_16x16x32_bf16 v[220:223], v[84:87], v[24:27], v[220:223]
    v_fma_f32 v133, v133, v101, v117
    v_fma_f32 v134, v134, v102, v118
    v_mfma_f32_16x16x32_bf16 v[220:223], v[80:83], v[20:23], v[220:223]
    v_fma_f32 v135, v135, v103, v119
    v_fma_f32 v148, v148, v100, v116
    v_mfma_f32_16x16x32_bf16 v[220:223], v[76:79], v[16:19], v[220:223]
    v_exp_f32 v111, v132
    v_mfma_f32_16x16x32_bf16 v[236:239], v[76:79], v[20:23], v[236:239]
    v_exp_f32 v110, v133
    v_mfma_f32_16x16x32_bf16 v[236:239], v[80:83], v[24:27], v[236:239]
    v_exp_f32 v109, v134
    v_mfma_f32_16x16x32_bf16 v[236:239], v[84:87], v[28:31], v[236:239]
    v_exp_f32 v108, v135
    v_mfma_f32_16x16x32_bf16 v[252:255], v[80:83], v[28:31], v[252:255]
    v_fma_f32 v111, v111, s46, s46
    v_fma_f32 v110, v110, s46, s46
    v_mfma_f32_16x16x32_bf16 v[252:255], v[76:79], v[24:27], v[252:255]
    v_fma_f32 v109, v109, s46, s46
    s_waitcnt lgkmcnt(0)
    v_mfma_f32_16x16x32_bf16 v[136:139], v[68:71], v[32:35], v[136:139]
    ds_read_b64_tr_b16 v[80:81], v93 offset:32768
    v_fma_f32 v108, v108, s46, s46
    v_mfma_f32_16x16x32_bf16 v[136:139], v[72:75], v[36:39], v[136:139]
    v_rcp_f32 v111, v111
    v_mfma_f32_16x16x32_bf16 v[152:155], v[72:75], v[40:43], v[152:155]
    v_rcp_f32 v110, v110
    v_mfma_f32_16x16x32_bf16 v[152:155], v[68:71], v[36:39], v[152:155]
    v_rcp_f32 v109, v109
    v_mfma_f32_16x16x32_bf16 v[152:155], v[64:67], v[32:35], v[152:155]
    v_rcp_f32 v108, v108
    v_mfma_f32_16x16x32_bf16 v[168:171], v[64:67], v[36:39], v[168:171]
    ds_read_b64_tr_b16 v[82:83], v93 offset:33792
    v_mul_f32 v132, v132, v111
    v_mfma_f32_16x16x32_bf16 v[168:171], v[68:71], v[40:43], v[168:171]
    ds_read_b64_tr_b16 v[84:85], v93 offset:40960
    v_mul_f32 v133, v133, v110
    v_mfma_f32_16x16x32_bf16 v[168:171], v[72:75], v[44:47], v[168:171]
    ds_read_b64_tr_b16 v[86:87], v93 offset:41984
    v_mul_f32 v134, v134, v109
    v_mfma_f32_16x16x32_bf16 v[184:187], v[72:75], v[48:51], v[184:187]
    ds_read_b64_tr_b16 v[76:77], v93 offset:24576
    v_mul_f32 v135, v135, v108
    v_mfma_f32_16x16x32_bf16 v[184:187], v[68:71], v[44:47], v[184:187]
    ds_read_b64_tr_b16 v[78:79], v93 offset:25600
    v_cvt_pk_bf16_f32 v132, v132, v133
    v_mfma_f32_16x16x32_bf16 v[184:187], v[64:67], v[40:43], v[184:187]
    ds_read_b128 v[0:3], v88 offset:32768
    v_cvt_pk_bf16_f32 v133, v134, v135
    v_mfma_f32_16x16x32_bf16 v[200:203], v[64:67], v[44:47], v[200:203]
    ds_read_b128 v[4:7], v88 offset:36864
    v_fma_f32 v149, v149, v101, v117
    v_mfma_f32_16x16x32_bf16 v[200:203], v[68:71], v[48:51], v[200:203]
    ds_read_b128 v[8:11], v88 offset:40960
    v_permlane16_swap_b32 v130, v132
    v_mfma_f32_16x16x32_bf16 v[200:203], v[72:75], v[52:55], v[200:203]
    ds_read_b128 v[12:15], v88 offset:45056
    v_permlane16_swap_b32 v131, v133
    v_mfma_f32_16x16x32_bf16 v[216:219], v[72:75], v[56:59], v[216:219]
    buffer_store_dwordx4 v[130:133], v95, s[12:15], s24 offen offset:0 sc1
    v_fma_f32 v150, v150, v102, v118
    v_mfma_f32_16x16x32_bf16 v[216:219], v[68:71], v[52:55], v[216:219]
    v_add_u32 v94, 49152, v92
    v_fma_f32 v151, v151, v103, v119
    v_mfma_f32_16x16x32_bf16 v[216:219], v[64:67], v[48:51], v[216:219]
    v_exp_f32 v107, v148
    v_mfma_f32_16x16x32_bf16 v[232:235], v[64:67], v[52:55], v[232:235]
    v_exp_f32 v106, v149
    v_mfma_f32_16x16x32_bf16 v[232:235], v[68:71], v[56:59], v[232:235]
    v_exp_f32 v105, v150
    v_mfma_f32_16x16x32_bf16 v[232:235], v[72:75], v[60:63], v[232:235]
    v_exp_f32 v104, v151
    v_mfma_f32_16x16x32_bf16 v[248:251], v[68:71], v[60:63], v[248:251]
    v_fma_f32 v107, v107, s46, s46
    v_fma_f32 v106, v106, s46, s46
    v_mfma_f32_16x16x32_bf16 v[248:251], v[64:67], v[56:59], v[248:251]
    v_fma_f32 v105, v105, s46, s46
    s_waitcnt lgkmcnt(2)
    v_mfma_f32_16x16x32_bf16 v[140:143], v[80:83], v[32:35], v[140:143]
    ds_read_b64_tr_b16 v[68:69], v94 offset:8192
    v_fma_f32 v104, v104, s46, s46
    v_mfma_f32_16x16x32_bf16 v[140:143], v[84:87], v[36:39], v[140:143]
    v_rcp_f32 v107, v107
    v_mfma_f32_16x16x32_bf16 v[156:159], v[84:87], v[40:43], v[156:159]
    v_rcp_f32 v106, v106
    v_mfma_f32_16x16x32_bf16 v[156:159], v[80:83], v[36:39], v[156:159]
    v_rcp_f32 v105, v105
    v_mfma_f32_16x16x32_bf16 v[156:159], v[76:79], v[32:35], v[156:159]
    v_rcp_f32 v104, v104
    v_mfma_f32_16x16x32_bf16 v[172:175], v[76:79], v[36:39], v[172:175]
    ds_read_b64_tr_b16 v[70:71], v94 offset:9216
    v_mul_f32 v148, v148, v107
    v_mfma_f32_16x16x32_bf16 v[172:175], v[80:83], v[40:43], v[172:175]
    ds_read_b64_tr_b16 v[72:73], v94 offset:16384
    v_mul_f32 v149, v149, v106
    v_mfma_f32_16x16x32_bf16 v[172:175], v[84:87], v[44:47], v[172:175]
    ds_read_b64_tr_b16 v[74:75], v94 offset:17408
    v_mul_f32 v150, v150, v105
    v_mfma_f32_16x16x32_bf16 v[188:191], v[84:87], v[48:51], v[188:191]
    ds_read_b64_tr_b16 v[64:65], v94 offset:0
    v_mul_f32 v151, v151, v104
    v_mfma_f32_16x16x32_bf16 v[188:191], v[80:83], v[44:47], v[188:191]
    ds_read_b64_tr_b16 v[66:67], v94 offset:1024
    v_cvt_pk_bf16_f32 v148, v148, v149
    v_mfma_f32_16x16x32_bf16 v[188:191], v[76:79], v[40:43], v[188:191]
    ds_read_b128 v[16:19], v88 offset:49152
    v_cvt_pk_bf16_f32 v149, v150, v151
    v_mfma_f32_16x16x32_bf16 v[204:207], v[76:79], v[44:47], v[204:207]
    ds_read_b128 v[20:23], v88 offset:53248
    v_fma_f32 v164, v164, v100, v116
    v_mfma_f32_16x16x32_bf16 v[204:207], v[80:83], v[48:51], v[204:207]
    ds_read_b128 v[24:27], v88 offset:57344
    v_permlane16_swap_b32 v146, v148
    v_mfma_f32_16x16x32_bf16 v[204:207], v[84:87], v[52:55], v[204:207]
    ds_read_b128 v[28:31], v88 offset:61440
    v_permlane16_swap_b32 v147, v149
    v_mfma_f32_16x16x32_bf16 v[220:223], v[84:87], v[56:59], v[220:223]
    buffer_store_dwordx4 v[146:149], v95, s[12:15], s24 offen offset:2048 sc1
    v_fma_f32 v165, v165, v101, v117
    v_mfma_f32_16x16x32_bf16 v[220:223], v[80:83], v[52:55], v[220:223]
    v_add_u32 v94, 49152, v93
    v_fma_f32 v166, v166, v102, v118
    v_mfma_f32_16x16x32_bf16 v[220:223], v[76:79], v[48:51], v[220:223]
    v_fma_f32 v167, v167, v103, v119
    v_fma_f32 v180, v180, v100, v116
    v_mfma_f32_16x16x32_bf16 v[236:239], v[76:79], v[52:55], v[236:239]
    v_exp_f32 v111, v164
    v_mfma_f32_16x16x32_bf16 v[236:239], v[80:83], v[56:59], v[236:239]
    v_exp_f32 v110, v165
    v_mfma_f32_16x16x32_bf16 v[236:239], v[84:87], v[60:63], v[236:239]
    v_exp_f32 v109, v166
    v_mfma_f32_16x16x32_bf16 v[252:255], v[80:83], v[60:63], v[252:255]
    v_exp_f32 v108, v167
    v_mfma_f32_16x16x32_bf16 v[252:255], v[76:79], v[56:59], v[252:255]
    v_fma_f32 v111, v111, s46, s46
    s_waitcnt lgkmcnt(2)
    v_mfma_f32_16x16x32_bf16 v[136:139], v[68:71], v[0:3], v[136:139]
    ds_read_b64_tr_b16 v[80:81], v94 offset:8192
    v_fma_f32 v110, v110, s46, s46
    v_mfma_f32_16x16x32_bf16 v[136:139], v[72:75], v[4:7], v[136:139]
    ds_read_b64_tr_b16 v[82:83], v94 offset:9216
    v_fma_f32 v109, v109, s46, s46
    v_mfma_f32_16x16x32_bf16 v[152:155], v[72:75], v[8:11], v[152:155]
    ds_read_b64_tr_b16 v[84:85], v94 offset:16384
    v_fma_f32 v108, v108, s46, s46
    v_mfma_f32_16x16x32_bf16 v[152:155], v[68:71], v[4:7], v[152:155]
    v_rcp_f32 v111, v111
    v_mfma_f32_16x16x32_bf16 v[152:155], v[64:67], v[0:3], v[152:155]
    v_rcp_f32 v110, v110
    v_mfma_f32_16x16x32_bf16 v[168:171], v[64:67], v[4:7], v[168:171]
    v_rcp_f32 v109, v109
    v_mfma_f32_16x16x32_bf16 v[168:171], v[68:71], v[8:11], v[168:171]
    v_rcp_f32 v108, v108
    v_mfma_f32_16x16x32_bf16 v[168:171], v[72:75], v[12:15], v[168:171]
    ds_read_b64_tr_b16 v[86:87], v94 offset:17408
    v_mul_f32 v164, v164, v111
    v_mfma_f32_16x16x32_bf16 v[184:187], v[72:75], v[16:19], v[184:187]
    ds_read_b64_tr_b16 v[76:77], v94 offset:0
    v_mul_f32 v165, v165, v110
    v_mfma_f32_16x16x32_bf16 v[184:187], v[68:71], v[12:15], v[184:187]
    ds_read_b64_tr_b16 v[78:79], v94 offset:1024
    v_mul_f32 v166, v166, v109
    v_mfma_f32_16x16x32_bf16 v[184:187], v[64:67], v[8:11], v[184:187]
    ds_read_b128 v[32:35], v89 offset:32768
    v_mul_f32 v167, v167, v108
    v_mfma_f32_16x16x32_bf16 v[200:203], v[64:67], v[12:15], v[200:203]
    ds_read_b128 v[36:39], v89 offset:36864
    v_cvt_pk_bf16_f32 v164, v164, v165
    v_mfma_f32_16x16x32_bf16 v[200:203], v[68:71], v[16:19], v[200:203]
    ds_read_b128 v[40:43], v89 offset:40960
    v_cvt_pk_bf16_f32 v165, v166, v167
    v_mfma_f32_16x16x32_bf16 v[200:203], v[72:75], v[20:23], v[200:203]
    ds_read_b128 v[44:47], v89 offset:45056
    s_waitcnt lgkmcnt(7)
    v_mfma_f32_16x16x32_bf16 v[216:219], v[72:75], v[24:27], v[216:219]
    v_add_u32 v94, 73728, v92
    v_permlane16_swap_b32 v162, v164
    v_mfma_f32_16x16x32_bf16 v[216:219], v[68:71], v[20:23], v[216:219]
    v_permlane16_swap_b32 v163, v165
    v_fma_f32 v181, v181, v101, v117
    v_mfma_f32_16x16x32_bf16 v[216:219], v[64:67], v[16:19], v[216:219]
    buffer_store_dwordx4 v[162:165], v95, s[12:15], s25 offen offset:0 sc1
    v_fma_f32 v182, v182, v102, v118
    v_mfma_f32_16x16x32_bf16 v[232:235], v[64:67], v[20:23], v[232:235]
    v_fma_f32 v183, v183, v103, v119
    v_fma_f32 v196, v196, v100, v116
    v_mfma_f32_16x16x32_bf16 v[232:235], v[68:71], v[24:27], v[232:235]
    v_exp_f32 v107, v180
    v_mfma_f32_16x16x32_bf16 v[232:235], v[72:75], v[28:31], v[232:235]
    v_exp_f32 v106, v181
    v_mfma_f32_16x16x32_bf16 v[248:251], v[68:71], v[28:31], v[248:251]
    v_exp_f32 v105, v182
    v_mfma_f32_16x16x32_bf16 v[248:251], v[64:67], v[24:27], v[248:251]
    v_fma_f32 v197, v197, v101, v117
    v_mfma_f32_16x16x32_bf16 v[140:143], v[80:83], v[0:3], v[140:143]
    ds_read_b64_tr_b16 v[68:69], v94 offset:8192
    s_waitcnt lgkmcnt(2)
    v_mfma_f32_16x16x32_bf16 v[140:143], v[84:87], v[4:7], v[140:143]
    v_exp_f32 v104, v183
    v_mfma_f32_16x16x32_bf16 v[156:159], v[84:87], v[8:11], v[156:159]
    ds_read_b64_tr_b16 v[70:71], v94 offset:9216
    v_fma_f32 v107, v107, s46, s46
    v_mfma_f32_16x16x32_bf16 v[156:159], v[80:83], v[4:7], v[156:159]
    ds_read_b64_tr_b16 v[72:73], v94 offset:16384
    v_fma_f32 v106, v106, s46, s46
    v_mfma_f32_16x16x32_bf16 v[156:159], v[76:79], v[0:3], v[156:159]
    ds_read_b64_tr_b16 v[74:75], v94 offset:17408
    v_fma_f32 v105, v105, s46, s46
    v_mfma_f32_16x16x32_bf16 v[172:175], v[76:79], v[4:7], v[172:175]
    ds_read_b64_tr_b16 v[64:65], v94 offset:0
    v_fma_f32 v104, v104, s46, s46
    v_mfma_f32_16x16x32_bf16 v[172:175], v[80:83], v[8:11], v[172:175]
    v_rcp_f32 v107, v107
    v_mfma_f32_16x16x32_bf16 v[172:175], v[84:87], v[12:15], v[172:175]
    v_rcp_f32 v106, v106
    v_mfma_f32_16x16x32_bf16 v[188:191], v[84:87], v[16:19], v[188:191]
    v_rcp_f32 v105, v105
    v_mfma_f32_16x16x32_bf16 v[188:191], v[80:83], v[12:15], v[188:191]
    v_rcp_f32 v104, v104
    v_mfma_f32_16x16x32_bf16 v[188:191], v[76:79], v[8:11], v[188:191]
    ds_read_b64_tr_b16 v[66:67], v94 offset:1024
    v_mul_f32 v180, v180, v107
    v_mfma_f32_16x16x32_bf16 v[204:207], v[76:79], v[12:15], v[204:207]
    ds_read_b128 v[48:51], v89 offset:49152
    v_mul_f32 v181, v181, v106
    v_mfma_f32_16x16x32_bf16 v[204:207], v[80:83], v[16:19], v[204:207]
    ds_read_b128 v[52:55], v89 offset:53248
    v_mul_f32 v182, v182, v105
    v_mfma_f32_16x16x32_bf16 v[204:207], v[84:87], v[20:23], v[204:207]
    ds_read_b128 v[56:59], v89 offset:57344
    v_mul_f32 v183, v183, v104
    v_mfma_f32_16x16x32_bf16 v[220:223], v[84:87], v[24:27], v[220:223]
    ds_read_b128 v[60:63], v89 offset:61440
    v_cvt_pk_bf16_f32 v180, v180, v181
    v_mfma_f32_16x16x32_bf16 v[220:223], v[80:83], v[20:23], v[220:223]
    v_add_u32 v94, 73728, v93
    v_cvt_pk_bf16_f32 v181, v182, v183
    v_mfma_f32_16x16x32_bf16 v[220:223], v[76:79], v[16:19], v[220:223]
    v_fma_f32 v198, v198, v102, v118
    v_fma_f32 v199, v199, v103, v119
    v_mfma_f32_16x16x32_bf16 v[236:239], v[76:79], v[20:23], v[236:239]
    v_exp_f32 v111, v196
    v_mfma_f32_16x16x32_bf16 v[236:239], v[80:83], v[24:27], v[236:239]
    v_exp_f32 v110, v197
    v_mfma_f32_16x16x32_bf16 v[236:239], v[84:87], v[28:31], v[236:239]
    v_exp_f32 v109, v198
    v_mfma_f32_16x16x32_bf16 v[252:255], v[80:83], v[28:31], v[252:255]
    v_exp_f32 v108, v199
    v_mfma_f32_16x16x32_bf16 v[252:255], v[76:79], v[24:27], v[252:255]
    v_permlane16_swap_b32 v178, v180
    s_waitcnt lgkmcnt(3)
    v_mfma_f32_16x16x32_bf16 v[136:139], v[68:71], v[32:35], v[136:139]
    ds_read_b64_tr_b16 v[80:81], v94 offset:8192
    v_permlane16_swap_b32 v179, v181
    v_mfma_f32_16x16x32_bf16 v[136:139], v[72:75], v[36:39], v[136:139]
    buffer_store_dwordx4 v[178:181], v95, s[12:15], s25 offen offset:2048 sc1
    v_fma_f32 v111, v111, s46, s46
    v_mfma_f32_16x16x32_bf16 v[152:155], v[72:75], v[40:43], v[152:155]
    ds_read_b64_tr_b16 v[82:83], v94 offset:9216
    v_fma_f32 v110, v110, s46, s46
    v_mfma_f32_16x16x32_bf16 v[152:155], v[68:71], v[36:39], v[152:155]
    ds_read_b64_tr_b16 v[84:85], v94 offset:16384
    v_fma_f32 v109, v109, s46, s46
    v_mfma_f32_16x16x32_bf16 v[152:155], v[64:67], v[32:35], v[152:155]
    ds_read_b64_tr_b16 v[86:87], v94 offset:17408
    v_fma_f32 v108, v108, s46, s46
    v_mfma_f32_16x16x32_bf16 v[168:171], v[64:67], v[36:39], v[168:171]
    v_rcp_f32 v111, v111
    v_mfma_f32_16x16x32_bf16 v[168:171], v[68:71], v[40:43], v[168:171]
    v_rcp_f32 v110, v110
    v_mfma_f32_16x16x32_bf16 v[168:171], v[72:75], v[44:47], v[168:171]
    v_rcp_f32 v109, v109
    v_mfma_f32_16x16x32_bf16 v[184:187], v[72:75], v[48:51], v[184:187]
    v_rcp_f32 v108, v108
    v_mfma_f32_16x16x32_bf16 v[184:187], v[68:71], v[44:47], v[184:187]
    ds_read_b64_tr_b16 v[76:77], v94 offset:0
    v_mul_f32 v196, v196, v111
    v_mfma_f32_16x16x32_bf16 v[184:187], v[64:67], v[40:43], v[184:187]
    ds_read_b64_tr_b16 v[78:79], v94 offset:1024
    v_mul_f32 v197, v197, v110
    v_mfma_f32_16x16x32_bf16 v[200:203], v[64:67], v[44:47], v[200:203]
    v_mul_f32 v198, v198, v109
    v_mul_f32 v199, v199, v108
    v_mfma_f32_16x16x32_bf16 v[200:203], v[68:71], v[48:51], v[200:203]
    v_cvt_pk_bf16_f32 v196, v196, v197
    s_waitcnt lgkmcnt(4)
    v_mfma_f32_16x16x32_bf16 v[200:203], v[72:75], v[52:55], v[200:203]
    v_cvt_pk_bf16_f32 v197, v198, v199
    v_fma_f32 v212, v212, v100, v116
    v_mfma_f32_16x16x32_bf16 v[216:219], v[72:75], v[56:59], v[216:219]
    v_fma_f32 v213, v213, v101, v117
    v_permlane16_swap_b32 v194, v196
    v_mfma_f32_16x16x32_bf16 v[216:219], v[68:71], v[52:55], v[216:219]
    v_permlane16_swap_b32 v195, v197
    v_fma_f32 v214, v214, v102, v118
    v_mfma_f32_16x16x32_bf16 v[216:219], v[64:67], v[48:51], v[216:219]
    buffer_store_dwordx4 v[194:197], v95, s[12:15], s26 offen offset:0 sc1
    v_fma_f32 v215, v215, v103, v119
    v_mfma_f32_16x16x32_bf16 v[232:235], v[64:67], v[52:55], v[232:235]
    v_exp_f32 v107, v212
    v_mfma_f32_16x16x32_bf16 v[232:235], v[68:71], v[56:59], v[232:235]
    v_exp_f32 v106, v213
    v_mfma_f32_16x16x32_bf16 v[232:235], v[72:75], v[60:63], v[232:235]
    v_exp_f32 v105, v214
    v_mfma_f32_16x16x32_bf16 v[248:251], v[68:71], v[60:63], v[248:251]
    v_exp_f32 v104, v215
    v_mfma_f32_16x16x32_bf16 v[248:251], v[64:67], v[56:59], v[248:251]
    v_fma_f32 v107, v107, s46, s46
    v_mfma_f32_16x16x32_bf16 v[140:143], v[80:83], v[32:35], v[140:143]
    v_fma_f32 v106, v106, s46, s46
    s_waitcnt lgkmcnt(0)
    v_mfma_f32_16x16x32_bf16 v[140:143], v[84:87], v[36:39], v[140:143]
    v_fma_f32 v105, v105, s46, s46
    v_fma_f32 v104, v104, s46, s46
    v_mfma_f32_16x16x32_bf16 v[156:159], v[84:87], v[40:43], v[156:159]
    v_rcp_f32 v107, v107
    v_mfma_f32_16x16x32_bf16 v[156:159], v[80:83], v[36:39], v[156:159]
    v_rcp_f32 v106, v106
    v_mfma_f32_16x16x32_bf16 v[156:159], v[76:79], v[32:35], v[156:159]
    v_rcp_f32 v105, v105
    v_mfma_f32_16x16x32_bf16 v[172:175], v[76:79], v[36:39], v[172:175]
    v_rcp_f32 v104, v104
    v_mfma_f32_16x16x32_bf16 v[172:175], v[80:83], v[40:43], v[172:175]
    v_mul_f32 v212, v212, v107
    v_mul_f32 v213, v213, v106
    v_mfma_f32_16x16x32_bf16 v[172:175], v[84:87], v[44:47], v[172:175]
    v_mul_f32 v214, v214, v105
    v_mul_f32 v215, v215, v104
    v_mfma_f32_16x16x32_bf16 v[188:191], v[84:87], v[48:51], v[188:191]
    v_cvt_pk_bf16_f32 v212, v212, v213
    v_cvt_pk_bf16_f32 v213, v214, v215
    v_mfma_f32_16x16x32_bf16 v[188:191], v[80:83], v[44:47], v[188:191]
    v_fma_f32 v224, v224, v96, v112
    v_fma_f32 v225, v225, v97, v113
    v_mfma_f32_16x16x32_bf16 v[188:191], v[76:79], v[40:43], v[188:191]
    v_permlane16_swap_b32 v210, v212
    v_permlane16_swap_b32 v211, v213
    v_mfma_f32_16x16x32_bf16 v[204:207], v[76:79], v[44:47], v[204:207]
    buffer_store_dwordx4 v[210:213], v95, s[12:15], s26 offen offset:2048 sc1
    v_fma_f32 v226, v226, v98, v114
    v_mfma_f32_16x16x32_bf16 v[204:207], v[80:83], v[48:51], v[204:207]
    v_fma_f32 v227, v227, v99, v115
    v_fma_f32 v228, v228, v100, v116
    v_mfma_f32_16x16x32_bf16 v[204:207], v[84:87], v[52:55], v[204:207]
    v_exp_f32 v111, v224
    v_mfma_f32_16x16x32_bf16 v[220:223], v[84:87], v[56:59], v[220:223]
    v_exp_f32 v110, v225
    v_mfma_f32_16x16x32_bf16 v[220:223], v[80:83], v[52:55], v[220:223]
    v_exp_f32 v109, v226
    v_mfma_f32_16x16x32_bf16 v[220:223], v[76:79], v[48:51], v[220:223]
    v_exp_f32 v108, v227
    v_mfma_f32_16x16x32_bf16 v[236:239], v[76:79], v[52:55], v[236:239]
    v_fma_f32 v111, v111, s46, s46
    v_fma_f32 v110, v110, s46, s46
    v_mfma_f32_16x16x32_bf16 v[236:239], v[80:83], v[56:59], v[236:239]
    v_fma_f32 v109, v109, s46, s46
    v_fma_f32 v108, v108, s46, s46
    v_mfma_f32_16x16x32_bf16 v[236:239], v[84:87], v[60:63], v[236:239]
    v_rcp_f32 v111, v111
    v_mfma_f32_16x16x32_bf16 v[252:255], v[80:83], v[60:63], v[252:255]
    v_rcp_f32 v110, v110
    v_mfma_f32_16x16x32_bf16 v[252:255], v[76:79], v[56:59], v[252:255]
    v_rcp_f32 v109, v109
    v_rcp_f32 v108, v108
    v_mul_f32 v224, v224, v111
    v_mul_f32 v225, v225, v110
    v_mul_f32 v226, v226, v109
    v_mul_f32 v227, v227, v108
    v_cvt_pk_bf16_f32 v227, v226, v227
    v_cvt_pk_bf16_f32 v226, v224, v225
    v_fma_f32 v229, v229, v101, v117
    v_fma_f32 v230, v230, v102, v118
    v_fma_f32 v231, v231, v103, v119
    v_exp_f32 v107, v228
    v_exp_f32 v106, v229
    v_exp_f32 v105, v230
    v_exp_f32 v104, v231
    v_fma_f32 v107, v107, s46, s46
    v_fma_f32 v106, v106, s46, s46
    v_fma_f32 v105, v105, s46, s46
    v_fma_f32 v104, v104, s46, s46
    v_rcp_f32 v107, v107
    v_rcp_f32 v106, v106
    v_rcp_f32 v105, v105
    v_rcp_f32 v104, v104
    v_mul_f32 v228, v228, v107
    v_mul_f32 v229, v229, v106
    v_mul_f32 v230, v230, v105
    v_mul_f32 v231, v231, v104
    v_cvt_pk_bf16_f32 v228, v228, v229
    v_cvt_pk_bf16_f32 v229, v230, v231
    s_nop 0
    s_nop 0
    s_nop 0
    v_permlane16_swap_b32 v226, v228
    v_permlane16_swap_b32 v227, v229
    buffer_store_dwordx4 v[226:229], v95, s[12:15], s27 offen offset:0 sc1
    v_mov_b64_dpp v[104:105], v[120:121] row_newbcast:0 row_mask:0xf bank_mask:0xf
    v_mov_b64_dpp v[106:107], v[120:121] row_newbcast:1 row_mask:0xf bank_mask:0xf
    v_mov_b64_dpp v[108:109], v[120:121] row_newbcast:2 row_mask:0xf bank_mask:0xf
    v_mov_b64_dpp v[110:111], v[120:121] row_newbcast:3 row_mask:0xf bank_mask:0xf
    v_mov_b64_dpp v[122:123], v[120:121] row_newbcast:5 row_mask:0xf bank_mask:0xf
    v_mov_b64_dpp v[124:125], v[120:121] row_newbcast:6 row_mask:0xf bank_mask:0xf
    v_mov_b64_dpp v[126:127], v[120:121] row_newbcast:7 row_mask:0xf bank_mask:0xf
    v_mov_b64_dpp v[120:121], v[120:121] row_newbcast:4 row_mask:0xf bank_mask:0xf
    v_pk_fma_f32 v[240:241], v[240:241], v[96:97], v[112:113]
    v_pk_fma_f32 v[242:243], v[242:243], v[98:99], v[114:115]
    v_pk_fma_f32 v[244:245], v[244:245], v[100:101], v[116:117]
    v_pk_fma_f32 v[246:247], v[246:247], v[102:103], v[118:119]
    v_exp_f32 v0, v240
    v_exp_f32 v1, v241
    v_exp_f32 v2, v242
    v_exp_f32 v3, v243
    v_exp_f32 v4, v244
    v_exp_f32 v5, v245
    v_exp_f32 v6, v246
    v_exp_f32 v7, v247
    v_pk_fma_f32 v[136:137], v[136:137], v[104:105], v[120:121]
    v_pk_fma_f32 v[138:139], v[138:139], v[106:107], v[122:123]
    v_pk_fma_f32 v[140:141], v[140:141], v[108:109], v[124:125]
    v_pk_fma_f32 v[142:143], v[142:143], v[110:111], v[126:127]
    v_pk_fma_f32 v[0:1], v[0:1], s[46:47], s[46:47]
    v_pk_fma_f32 v[2:3], v[2:3], s[46:47], s[46:47]
    v_pk_fma_f32 v[4:5], v[4:5], s[46:47], s[46:47]
    v_pk_fma_f32 v[6:7], v[6:7], s[46:47], s[46:47]
    v_rcp_f32 v0, v0
    v_rcp_f32 v1, v1
    v_rcp_f32 v2, v2
    v_rcp_f32 v3, v3
    v_rcp_f32 v4, v4
    v_rcp_f32 v5, v5
    v_rcp_f32 v6, v6
    v_rcp_f32 v7, v7
    v_pk_mul_f32 v[240:241], v[240:241], v[0:1]
    v_pk_mul_f32 v[242:243], v[242:243], v[2:3]
    v_pk_mul_f32 v[244:245], v[244:245], v[4:5]
    v_pk_mul_f32 v[246:247], v[246:247], v[6:7]
    v_cvt_pk_bf16_f32 v243, v242, v243
    v_cvt_pk_bf16_f32 v242, v240, v241
    v_cvt_pk_bf16_f32 v244, v244, v245
    v_cvt_pk_bf16_f32 v245, v246, v247
    v_exp_f32 v8, v136
    v_exp_f32 v9, v137
    v_exp_f32 v10, v138
    v_exp_f32 v11, v139
    v_exp_f32 v12, v140
    v_exp_f32 v13, v141
    v_exp_f32 v14, v142
    v_exp_f32 v15, v143
    v_pk_fma_f32 v[152:153], v[152:153], v[104:105], v[120:121]
    v_pk_fma_f32 v[154:155], v[154:155], v[106:107], v[122:123]
    v_pk_fma_f32 v[156:157], v[156:157], v[108:109], v[124:125]
    v_pk_fma_f32 v[158:159], v[158:159], v[110:111], v[126:127]
    v_pk_fma_f32 v[8:9], v[8:9], s[46:47], s[46:47]
    v_pk_fma_f32 v[10:11], v[10:11], s[46:47], s[46:47]
    v_pk_fma_f32 v[12:13], v[12:13], s[46:47], s[46:47]
    v_pk_fma_f32 v[14:15], v[14:15], s[46:47], s[46:47]
    v_permlane16_swap_b32 v242, v244
    v_permlane16_swap_b32 v243, v245
    buffer_store_dwordx4 v[242:245], v95, s[12:15], s27 offen offset:2048 sc1
    v_rcp_f32 v8, v8
    v_rcp_f32 v9, v9
    v_rcp_f32 v10, v10
    v_rcp_f32 v11, v11
    v_rcp_f32 v12, v12
    v_rcp_f32 v13, v13
    v_rcp_f32 v14, v14
    v_rcp_f32 v15, v15
    v_pk_mul_f32 v[136:137], v[136:137], v[8:9]
    v_pk_mul_f32 v[138:139], v[138:139], v[10:11]
    v_pk_mul_f32 v[140:141], v[140:141], v[12:13]
    v_pk_mul_f32 v[142:143], v[142:143], v[14:15]
    v_cvt_pk_bf16_f32 v139, v138, v139
    v_cvt_pk_bf16_f32 v138, v136, v137
    v_cvt_pk_bf16_f32 v140, v140, v141
    v_cvt_pk_bf16_f32 v141, v142, v143
    v_exp_f32 v0, v152
    v_exp_f32 v1, v153
    v_exp_f32 v2, v154
    v_exp_f32 v3, v155
    v_exp_f32 v4, v156
    v_exp_f32 v5, v157
    v_exp_f32 v6, v158
    v_exp_f32 v7, v159
    v_pk_fma_f32 v[168:169], v[168:169], v[104:105], v[120:121]
    v_pk_fma_f32 v[170:171], v[170:171], v[106:107], v[122:123]
    v_pk_fma_f32 v[172:173], v[172:173], v[108:109], v[124:125]
    v_pk_fma_f32 v[174:175], v[174:175], v[110:111], v[126:127]
    v_pk_fma_f32 v[0:1], v[0:1], s[46:47], s[46:47]
    v_pk_fma_f32 v[2:3], v[2:3], s[46:47], s[46:47]
    v_pk_fma_f32 v[4:5], v[4:5], s[46:47], s[46:47]
    v_pk_fma_f32 v[6:7], v[6:7], s[46:47], s[46:47]
    v_permlane16_swap_b32 v138, v140
    v_permlane16_swap_b32 v139, v141
    buffer_store_dwordx4 v[138:141], v95, s[12:15], s24 offen offset:64 sc1
    v_rcp_f32 v0, v0
    v_rcp_f32 v1, v1
    v_rcp_f32 v2, v2
    v_rcp_f32 v3, v3
    v_rcp_f32 v4, v4
    v_rcp_f32 v5, v5
    v_rcp_f32 v6, v6
    v_rcp_f32 v7, v7
    v_pk_mul_f32 v[152:153], v[152:153], v[0:1]
    v_pk_mul_f32 v[154:155], v[154:155], v[2:3]
    v_pk_mul_f32 v[156:157], v[156:157], v[4:5]
    v_pk_mul_f32 v[158:159], v[158:159], v[6:7]
    v_cvt_pk_bf16_f32 v155, v154, v155
    v_cvt_pk_bf16_f32 v154, v152, v153
    v_cvt_pk_bf16_f32 v156, v156, v157
    v_cvt_pk_bf16_f32 v157, v158, v159
    v_exp_f32 v8, v168
    v_exp_f32 v9, v169
    v_exp_f32 v10, v170
    v_exp_f32 v11, v171
    v_exp_f32 v12, v172
    v_exp_f32 v13, v173
    v_exp_f32 v14, v174
    v_exp_f32 v15, v175
    v_pk_fma_f32 v[184:185], v[184:185], v[104:105], v[120:121]
    v_pk_fma_f32 v[186:187], v[186:187], v[106:107], v[122:123]
    v_pk_fma_f32 v[188:189], v[188:189], v[108:109], v[124:125]
    v_pk_fma_f32 v[190:191], v[190:191], v[110:111], v[126:127]
    v_pk_fma_f32 v[8:9], v[8:9], s[46:47], s[46:47]
    v_pk_fma_f32 v[10:11], v[10:11], s[46:47], s[46:47]
    v_pk_fma_f32 v[12:13], v[12:13], s[46:47], s[46:47]
    v_pk_fma_f32 v[14:15], v[14:15], s[46:47], s[46:47]
    v_permlane16_swap_b32 v154, v156
    v_permlane16_swap_b32 v155, v157
    buffer_store_dwordx4 v[154:157], v95, s[12:15], s24 offen offset:2112 sc1
    v_rcp_f32 v8, v8
    v_rcp_f32 v9, v9
    v_rcp_f32 v10, v10
    v_rcp_f32 v11, v11
    v_rcp_f32 v12, v12
    v_rcp_f32 v13, v13
    v_rcp_f32 v14, v14
    v_rcp_f32 v15, v15
    v_pk_mul_f32 v[168:169], v[168:169], v[8:9]
    v_pk_mul_f32 v[170:171], v[170:171], v[10:11]
    v_pk_mul_f32 v[172:173], v[172:173], v[12:13]
    v_pk_mul_f32 v[174:175], v[174:175], v[14:15]
    v_cvt_pk_bf16_f32 v171, v170, v171
    v_cvt_pk_bf16_f32 v170, v168, v169
    v_cvt_pk_bf16_f32 v172, v172, v173
    v_cvt_pk_bf16_f32 v173, v174, v175
    v_exp_f32 v0, v184
    v_exp_f32 v1, v185
    v_exp_f32 v2, v186
    v_exp_f32 v3, v187
    v_exp_f32 v4, v188
    v_exp_f32 v5, v189
    v_exp_f32 v6, v190
    v_exp_f32 v7, v191
    v_pk_fma_f32 v[200:201], v[200:201], v[104:105], v[120:121]
    v_pk_fma_f32 v[202:203], v[202:203], v[106:107], v[122:123]
    v_pk_fma_f32 v[204:205], v[204:205], v[108:109], v[124:125]
    v_pk_fma_f32 v[206:207], v[206:207], v[110:111], v[126:127]
    v_pk_fma_f32 v[0:1], v[0:1], s[46:47], s[46:47]
    v_pk_fma_f32 v[2:3], v[2:3], s[46:47], s[46:47]
    v_pk_fma_f32 v[4:5], v[4:5], s[46:47], s[46:47]
    v_pk_fma_f32 v[6:7], v[6:7], s[46:47], s[46:47]
    v_permlane16_swap_b32 v170, v172
    v_permlane16_swap_b32 v171, v173
    buffer_store_dwordx4 v[170:173], v95, s[12:15], s25 offen offset:64 sc1
    v_rcp_f32 v0, v0
    v_rcp_f32 v1, v1
    v_rcp_f32 v2, v2
    v_rcp_f32 v3, v3
    v_rcp_f32 v4, v4
    v_rcp_f32 v5, v5
    v_rcp_f32 v6, v6
    v_rcp_f32 v7, v7
    v_pk_mul_f32 v[184:185], v[184:185], v[0:1]
    v_pk_mul_f32 v[186:187], v[186:187], v[2:3]
    v_pk_mul_f32 v[188:189], v[188:189], v[4:5]
    v_pk_mul_f32 v[190:191], v[190:191], v[6:7]
    v_cvt_pk_bf16_f32 v187, v186, v187
    v_cvt_pk_bf16_f32 v186, v184, v185
    v_cvt_pk_bf16_f32 v188, v188, v189
    v_cvt_pk_bf16_f32 v189, v190, v191
    v_exp_f32 v8, v200
    v_exp_f32 v9, v201
    v_exp_f32 v10, v202
    v_exp_f32 v11, v203
    v_exp_f32 v12, v204
    v_exp_f32 v13, v205
    v_exp_f32 v14, v206
    v_exp_f32 v15, v207
    v_pk_fma_f32 v[216:217], v[216:217], v[104:105], v[120:121]
    v_pk_fma_f32 v[218:219], v[218:219], v[106:107], v[122:123]
    v_pk_fma_f32 v[220:221], v[220:221], v[108:109], v[124:125]
    v_pk_fma_f32 v[222:223], v[222:223], v[110:111], v[126:127]
    v_pk_fma_f32 v[8:9], v[8:9], s[46:47], s[46:47]
    v_pk_fma_f32 v[10:11], v[10:11], s[46:47], s[46:47]
    v_pk_fma_f32 v[12:13], v[12:13], s[46:47], s[46:47]
    v_pk_fma_f32 v[14:15], v[14:15], s[46:47], s[46:47]
    v_permlane16_swap_b32 v186, v188
    v_permlane16_swap_b32 v187, v189
    buffer_store_dwordx4 v[186:189], v95, s[12:15], s25 offen offset:2112 sc1
    v_rcp_f32 v8, v8
    v_rcp_f32 v9, v9
    v_rcp_f32 v10, v10
    v_rcp_f32 v11, v11
    v_rcp_f32 v12, v12
    v_rcp_f32 v13, v13
    v_rcp_f32 v14, v14
    v_rcp_f32 v15, v15
    v_pk_mul_f32 v[200:201], v[200:201], v[8:9]
    v_pk_mul_f32 v[202:203], v[202:203], v[10:11]
    v_pk_mul_f32 v[204:205], v[204:205], v[12:13]
    v_pk_mul_f32 v[206:207], v[206:207], v[14:15]
    v_cvt_pk_bf16_f32 v203, v202, v203
    v_cvt_pk_bf16_f32 v202, v200, v201
    v_cvt_pk_bf16_f32 v204, v204, v205
    v_cvt_pk_bf16_f32 v205, v206, v207
    v_exp_f32 v0, v216
    v_exp_f32 v1, v217
    v_exp_f32 v2, v218
    v_exp_f32 v3, v219
    v_exp_f32 v4, v220
    v_exp_f32 v5, v221
    v_exp_f32 v6, v222
    v_exp_f32 v7, v223
    v_pk_fma_f32 v[232:233], v[232:233], v[104:105], v[120:121]
    v_pk_fma_f32 v[234:235], v[234:235], v[106:107], v[122:123]
    v_pk_fma_f32 v[236:237], v[236:237], v[108:109], v[124:125]
    v_pk_fma_f32 v[238:239], v[238:239], v[110:111], v[126:127]
    v_pk_fma_f32 v[0:1], v[0:1], s[46:47], s[46:47]
    v_pk_fma_f32 v[2:3], v[2:3], s[46:47], s[46:47]
    v_pk_fma_f32 v[4:5], v[4:5], s[46:47], s[46:47]
    v_pk_fma_f32 v[6:7], v[6:7], s[46:47], s[46:47]
    v_permlane16_swap_b32 v202, v204
    v_permlane16_swap_b32 v203, v205
    buffer_store_dwordx4 v[202:205], v95, s[12:15], s26 offen offset:64 sc1
    v_rcp_f32 v0, v0
    v_rcp_f32 v1, v1
    v_rcp_f32 v2, v2
    v_rcp_f32 v3, v3
    v_rcp_f32 v4, v4
    v_rcp_f32 v5, v5
    v_rcp_f32 v6, v6
    v_rcp_f32 v7, v7
    v_pk_mul_f32 v[216:217], v[216:217], v[0:1]
    v_pk_mul_f32 v[218:219], v[218:219], v[2:3]
    v_pk_mul_f32 v[220:221], v[220:221], v[4:5]
    v_pk_mul_f32 v[222:223], v[222:223], v[6:7]
    v_cvt_pk_bf16_f32 v219, v218, v219
    v_cvt_pk_bf16_f32 v218, v216, v217
    v_cvt_pk_bf16_f32 v220, v220, v221
    v_cvt_pk_bf16_f32 v221, v222, v223
    v_exp_f32 v8, v232
    v_exp_f32 v9, v233
    v_exp_f32 v10, v234
    v_exp_f32 v11, v235
    v_exp_f32 v12, v236
    v_exp_f32 v13, v237
    v_exp_f32 v14, v238
    v_exp_f32 v15, v239
    v_pk_fma_f32 v[248:249], v[248:249], v[104:105], v[120:121]
    v_pk_fma_f32 v[250:251], v[250:251], v[106:107], v[122:123]
    v_pk_fma_f32 v[252:253], v[252:253], v[108:109], v[124:125]
    v_pk_fma_f32 v[254:255], v[254:255], v[110:111], v[126:127]
    v_pk_fma_f32 v[8:9], v[8:9], s[46:47], s[46:47]
    v_pk_fma_f32 v[10:11], v[10:11], s[46:47], s[46:47]
    v_pk_fma_f32 v[12:13], v[12:13], s[46:47], s[46:47]
    v_pk_fma_f32 v[14:15], v[14:15], s[46:47], s[46:47]
    v_permlane16_swap_b32 v218, v220
    v_permlane16_swap_b32 v219, v221
    buffer_store_dwordx4 v[218:221], v95, s[12:15], s26 offen offset:2112 sc1
    v_rcp_f32 v8, v8
    v_rcp_f32 v9, v9
    v_rcp_f32 v10, v10
    v_rcp_f32 v11, v11
    v_rcp_f32 v12, v12
    v_rcp_f32 v13, v13
    v_rcp_f32 v14, v14
    v_rcp_f32 v15, v15
    v_pk_mul_f32 v[232:233], v[232:233], v[8:9]
    v_pk_mul_f32 v[234:235], v[234:235], v[10:11]
    v_pk_mul_f32 v[236:237], v[236:237], v[12:13]
    v_pk_mul_f32 v[238:239], v[238:239], v[14:15]
    v_cvt_pk_bf16_f32 v235, v234, v235
    v_cvt_pk_bf16_f32 v234, v232, v233
    v_cvt_pk_bf16_f32 v236, v236, v237
    v_cvt_pk_bf16_f32 v237, v238, v239
    v_exp_f32 v0, v248
    v_exp_f32 v1, v249
    v_exp_f32 v2, v250
    v_exp_f32 v3, v251
    v_exp_f32 v4, v252
    v_exp_f32 v5, v253
    v_exp_f32 v6, v254
    v_exp_f32 v7, v255
    v_pk_fma_f32 v[0:1], v[0:1], s[46:47], s[46:47]
    v_pk_fma_f32 v[2:3], v[2:3], s[46:47], s[46:47]
    v_pk_fma_f32 v[4:5], v[4:5], s[46:47], s[46:47]
    v_pk_fma_f32 v[6:7], v[6:7], s[46:47], s[46:47]
    v_permlane16_swap_b32 v234, v236
    v_permlane16_swap_b32 v235, v237
    buffer_store_dwordx4 v[234:237], v95, s[12:15], s27 offen offset:64 sc1
    v_rcp_f32 v0, v0
    v_rcp_f32 v1, v1
    v_rcp_f32 v2, v2
    v_rcp_f32 v3, v3
    v_rcp_f32 v4, v4
    v_rcp_f32 v5, v5
    v_rcp_f32 v6, v6
    v_rcp_f32 v7, v7
    v_pk_mul_f32 v[248:249], v[248:249], v[0:1]
    v_pk_mul_f32 v[250:251], v[250:251], v[2:3]
    v_pk_mul_f32 v[252:253], v[252:253], v[4:5]
    v_pk_mul_f32 v[254:255], v[254:255], v[6:7]
    v_cvt_pk_bf16_f32 v251, v250, v251
    v_cvt_pk_bf16_f32 v250, v248, v249
    v_cvt_pk_bf16_f32 v252, v252, v253
    v_cvt_pk_bf16_f32 v253, v254, v255
    s_nop 1
    v_permlane16_swap_b32 v250, v252
    v_permlane16_swap_b32 v251, v253
    buffer_store_dwordx4 v[250:253], v95, s[12:15], s27 offen offset:2112 sc1
L_end:
    s_endpgm
.section .rodata,"a"
.p2align 6
.amdhsa_kernel standalone__batchnorm__sampling_kernel
  .amdhsa_next_free_vgpr 256
  .amdhsa_next_free_sgpr 96
  .amdhsa_accum_offset 256
  .amdhsa_group_segment_fixed_size 0
  .amdhsa_kernarg_size 72
  .amdhsa_user_sgpr_count 2
  .amdhsa_user_sgpr_kernarg_segment_ptr 1
  .amdhsa_system_sgpr_workgroup_id_x 1
  .amdhsa_float_denorm_mode_32 3
.end_amdhsa_kernel
```
